```python
import torch

def _softmax(x, axis=-1):
    return torch.softmax(x, dim=axis)
def _gelu(x):
    return torch.nn.functional.gelu(x, approximate="tanh")
def _silu(x):
    return torch.nn.functional.silu(x)
def _sigmoid(x):
    return torch.sigmoid(x)
def _layernorm(x, axis=-1, eps=1e-5):
    m = x.mean(dim=axis, keepdim=True)
    v = x.var(dim=axis, keepdim=True, unbiased=False)
    return (x - m) / torch.sqrt(v + eps)
def _scatter_add(tgt, idx, src, axis=0):
    return tgt.clone().index_add_(axis, idx, src)
def _segment_sum(src, seg, n):
    out = torch.zeros((n,) + src.shape[1:], dtype=src.dtype)
    return out.index_add_(0, seg, src)
def _pad(x, pw):
    flat = tuple(v for pair in reversed(pw) for v in pair)
    return torch.nn.functional.pad(x, flat)

kernel_name = 'concat_heads__gqa_block_cached__gqa_block_cached__near_ridge'

def setup_inputs():

    _w = (lambda a: (lambda t: t.to(torch.bfloat16) if t.is_floating_point() else t)(torch.as_tensor(a)))
    def _A_setup():
        B, Sq, D = 8, 112, 576
        Hq, Hkv, Sk, Dh = 32, 16, 512, 128
        assert Hq % Hkv == 0, (Hq, Hkv)
        return {
            "x": _w((lambda *s: torch.randn(*s, dtype=torch.bfloat16) * 0.8)(B, Sq, D)),
            "k_cache": _w((lambda *s: torch.randn(*s, dtype=torch.bfloat16) * 0.8)(B, Hkv, Sk, Dh)),
            "v_cache": _w((lambda *s: torch.randn(*s, dtype=torch.bfloat16) * 0.05)(B, Hkv, Sk, Dh)),
            "wq": _w((lambda *s: torch.randn(*s, dtype=torch.bfloat16) * 0.8)(D, Hq * Dh) * (D ** -0.5)),
            "wo": _w((lambda *s: torch.randn(*s, dtype=torch.bfloat16) * 0.05)(Hq * Dh, D) * ((Hq * Dh) ** -0.5)),
        }
    _A_in = _A_setup()

    def _B_setup():
        B, Sq, D = 8, 112, 576
        Hq, Hkv, Sk, Dh = 32, 16, 512, 128
        assert Hq % Hkv == 0, (Hq, Hkv)
        return {
            "x": _w((lambda *s: torch.randn(*s, dtype=torch.bfloat16) * 0.8)(B, Sq, D)),
            "k_cache": _w((lambda *s: torch.randn(*s, dtype=torch.bfloat16) * 0.8)(B, Hkv, Sk, Dh)),
            "v_cache": _w((lambda *s: torch.randn(*s, dtype=torch.bfloat16) * 0.05)(B, Hkv, Sk, Dh)),
            "wq": _w((lambda *s: torch.randn(*s, dtype=torch.bfloat16) * 0.8)(D, Hq * Dh) * (D ** -0.5)),
            "wo": _w((lambda *s: torch.randn(*s, dtype=torch.bfloat16) * 0.05)(Hq * Dh, D) * ((Hq * Dh) ** -0.5)),
        }
    _B_in = _B_setup()

    return {
        "A_x": _A_in["x"],
        "A_k_cache": _A_in["k_cache"],
        "A_v_cache": _A_in["v_cache"],
        "A_wq": _A_in["wq"],
        "A_wo": _A_in["wo"],
        "B_x": _B_in["x"],
        "B_k_cache": _B_in["k_cache"],
        "B_v_cache": _B_in["v_cache"],
        "B_wq": _B_in["wq"],
        "B_wo": _B_in["wo"],
    }

def reference(A_x, A_k_cache, A_v_cache, A_wq, A_wo, B_x, B_k_cache, B_v_cache, B_wq, B_wo):
    def _A_ref(x, k_cache, v_cache, wq, wo):
        B, Sq, D = x.shape
        Hq, Dh = 32, 128
        Hkv = k_cache.shape[1]
        rep = Hq // Hkv
        q = (lambda x, *d: x.permute(*d))((x @ wq).reshape(B, Sq, Hq, Dh), 0, 2, 1, 3)
        k = (lambda x, n, axis: torch.repeat_interleave(x, n, dim=axis))(k_cache, rep, axis=1)
        v = (lambda x, n, axis: torch.repeat_interleave(x, n, dim=axis))(v_cache, rep, axis=1)
        scores = torch.einsum("bhqd,bhkd->bhqk", q, k) * (Dh ** -0.5)
        p = _softmax(scores, axis=-1)
        o = torch.einsum("bhqk,bhkd->bhqd", p, v)
        return (lambda x, *d: x.permute(*d))(o, 0, 2, 1, 3).reshape(B, Sq, Hq * Dh) @ wo

    def _B_ref(x, k_cache, v_cache, wq, wo):
        B, Sq, D = x.shape
        Hq, Dh = 32, 128
        Hkv = k_cache.shape[1]
        rep = Hq // Hkv
        q = (lambda x, *d: x.permute(*d))((x @ wq).reshape(B, Sq, Hq, Dh), 0, 2, 1, 3)
        k = (lambda x, n, axis: torch.repeat_interleave(x, n, dim=axis))(k_cache, rep, axis=1)
        v = (lambda x, n, axis: torch.repeat_interleave(x, n, dim=axis))(v_cache, rep, axis=1)
        scores = torch.einsum("bhqd,bhkd->bhqk", q, k) * (Dh ** -0.5)
        p = _softmax(scores, axis=-1)
        o = torch.einsum("bhqk,bhkd->bhqd", p, v)
        return (lambda x, *d: x.permute(*d))(o, 0, 2, 1, 3).reshape(B, Sq, Hq * Dh) @ wo

    a = _A_ref(A_x, A_k_cache, A_v_cache, A_wq, A_wo)
    b = _B_ref(B_x, B_k_cache, B_v_cache, B_wq, B_wo)
    return torch.concatenate([a, b], axis=-1)
```

```asm
; @launch kernel=k1_kernel grid=(256,1,1) block=(512,1,1) lds=163840
.amdgcn_target "amdgcn-amd-amdhsa--gfx950"
.text
.p2align 8
.globl k1_kernel
.type k1_kernel,@function
k1_kernel:
K1_BEGIN:
    s_cmp_ge_u32 s2, 256
    s_cbranch_scc1 K1_END
    s_load_dwordx8 s[8:15], s[0:1], 0
    s_load_dwordx8 s[16:23], s[0:1], 40
    s_load_dwordx2 s[24:25], s[0:1], 96
    s_and_b32 s3, s2, 7
    s_lshr_b32 s4, s2, 3
    s_lshr_b32 s26, s3, 2
    s_and_b32 s3, s3, 3
    s_lshl_b32 s3, s3, 2
    s_and_b32 s27, s4, 3
    s_add_u32 s27, s27, s3
    s_lshr_b32 s4, s4, 2
    v_lshrrev_b32 v1, 6, v0
    s_nop 0
    v_readfirstlane_b32 s5, v1
    v_and_b32 v0, 63, v0
    s_bfe_u32 s6, s5, 0x10001
    s_and_b32 s7, s5, 1
    s_lshl_b32 s7, s7, 1
    s_lshr_b32 s3, s5, 2
    s_add_u32 s7, s7, s3
    s_lshl_b32 s48, s5, 11
    s_and_b32 s58, s5, 3
    s_lshl_b32 s59, s58, 11
    s_mul_i32 s49, s4, 129024
    s_lshl_b32 s50, s27, 9
    s_lshl_b32 s51, s4, 4
    s_add_u32 s51, s51, s27
    s_lshl_b32 s54, s54, 14
    s_lshl_b32 s51, s51, 17
    s_mov_b32 s56, 0x4b800000
    s_mov_b32 s57, 0x3e0293ee
    v_lshrrev_b32 v1, 3, v0
    s_lshl_b32 s3, s58, 4
    s_add_u32 s3, s3, 0
    v_add_u32 v1, s3, v1
    v_mul_u32_u24 v1, 1152, v1
    v_and_b32 v2, 7, v0
    v_lshrrev_b32 v3, 4, v0
    v_xor_b32 v2, v2, v3
    v_lshl_add_u32 v8, v2, 4, v1
    v_lshrrev_b32 v3, 5, v0
    s_lshl_b32 s3, s58, 2
    s_add_u32 s3, s3, 0
    v_add_u32 v1, s3, v3
    v_lshlrev_b32 v1, 13, v1
    v_or_b32 v3, 0, v3
    v_lshlrev_b32 v3, 2, v3
    v_and_b32 v2, 31, v0
    v_xor_b32 v2, v2, v3
    v_lshl_add_u32 v10, v2, 4, v1
    v_lshrrev_b32 v3, 4, v0
    s_lshl_b32 s3, s5, 3
    s_add_u32 s3, s3, 0
    v_add_u32 v1, s3, v3
    v_lshlrev_b32 v1, 8, v1
    s_and_b32 s3, s5, 1
    s_lshl_b32 s3, s3, 1
    s_or_b32 s3, s3, 0
    v_lshlrev_b32 v3, 2, v3
    v_or_b32 v3, s3, v3
    v_and_b32 v2, 15, v0
    v_xor_b32 v2, v2, v3
    v_lshl_add_u32 v12, v2, 4, v1
    v_lshrrev_b32 v1, 3, v0
    s_lshl_b32 s3, s58, 4
    s_add_u32 s3, s3, 8
    v_add_u32 v1, s3, v1
    v_mul_u32_u24 v1, 1152, v1
    v_and_b32 v2, 7, v0
    v_lshrrev_b32 v3, 4, v0
    v_xor_b32 v2, v2, v3
    v_xor_b32 v2, 4, v2
    v_lshl_add_u32 v9, v2, 4, v1
    v_lshrrev_b32 v3, 5, v0
    s_lshl_b32 s3, s58, 2
    s_add_u32 s3, s3, 2
    v_add_u32 v1, s3, v3
    v_lshlrev_b32 v1, 13, v1
    v_or_b32 v3, 2, v3
    v_lshlrev_b32 v3, 2, v3
    v_and_b32 v2, 31, v0
    v_xor_b32 v2, v2, v3
    v_lshl_add_u32 v11, v2, 4, v1
    v_lshrrev_b32 v3, 4, v0
    s_lshl_b32 s3, s5, 3
    s_add_u32 s3, s3, 4
    v_add_u32 v1, s3, v3
    v_lshlrev_b32 v1, 8, v1
    s_and_b32 s3, s5, 1
    s_lshl_b32 s3, s3, 1
    s_or_b32 s3, s3, 1
    v_lshlrev_b32 v3, 2, v3
    v_or_b32 v3, s3, v3
    v_and_b32 v2, 15, v0
    v_xor_b32 v2, v2, v3
    v_lshl_add_u32 v13, v2, 4, v1
    v_lshrrev_b32 v1, 5, v0
    v_bfe_u32 v2, v0, 4, 1
    v_bfe_u32 v3, v0, 2, 2
    v_and_b32 v4, 3, v0
    v_and_b32 v5, 31, v0
    v_lshl_add_u32 v6, v1, 3, v3
    v_lshlrev_b32 v6, 9, v6
    v_lshlrev_b32 v7, 2, v3
    v_lshl_add_u32 v7, v2, 1, v7
    v_and_b32 v14, 1, v4
    v_add_u32 v7, v7, v14
    s_lshl_b32 s3, s6, 4
    v_add_u32 v7, s3, v7
    v_lshl_add_u32 v6, v7, 4, v6
    v_lshrrev_b32 v7, 1, v4
    v_lshl_add_u32 v14, v7, 3, v6
    s_lshl_b32 s3, s7, 5
    v_add_u32 v6, s3, v5
    v_lshlrev_b32 v6, 7, v6
    v_bfe_u32 v7, v5, 1, 3
    v_xor_b32 v7, v7, v1
    v_lshl_add_u32 v15, v7, 4, v6
    v_lshlrev_b32 v6, 2, v4
    v_or_b32 v6, v6, v3
    v_xor_b32 v6, v6, v1
    v_lshlrev_b32 v7, 8, v5
    v_lshl_add_u32 v16, v6, 4, v7
    v_lshl_add_u32 v6, v1, 2, v3
    v_lshlrev_b32 v6, 8, v6
    v_lshrrev_b32 v7, 1, v4
    v_lshl_add_u32 v7, v2, 1, v7
    v_xor_b32 v7, v7, v1
    v_lshl_or_b32 v7, v3, 2, v7
    v_lshl_add_u32 v6, v7, 4, v6
    v_and_b32 v7, 1, v4
    v_lshl_add_u32 v17, v7, 3, v6
    v_lshlrev_b32 v6, 17, v2
    v_lshl_add_u32 v6, v1, 8, v6
    v_and_b32 v7, 15, v0
    v_lshl_add_u32 v19, v7, 4, v6
    v_mov_b32 v18, 0
    s_waitcnt lgkmcnt(0)
    s_cmp_eq_u32 s26, 0
    s_cselect_b32 s8, s8, s16
    s_cselect_b32 s9, s9, s17
    s_cselect_b32 s10, s10, s18
    s_cselect_b32 s11, s11, s19
    s_cselect_b32 s12, s12, s20
    s_cselect_b32 s13, s13, s21
    s_cselect_b32 s14, s14, s22
    s_cselect_b32 s15, s15, s23
    s_mov_b32 s28, s8
    s_and_b32 s29, s9, 0xffff
    s_mov_b32 s30, 1032192
    s_mov_b32 s31, 0x00020000
    s_mov_b32 s36, s10
    s_and_b32 s37, s11, 0xffff
    s_mov_b32 s38, 16777216
    s_mov_b32 s39, 0x00020000
    s_mov_b32 s40, s12
    s_and_b32 s41, s13, 0xffff
    s_mov_b32 s42, 16777216
    s_mov_b32 s43, 0x00020000
    s_mov_b32 s32, s14
    s_and_b32 s33, s15, 0xffff
    s_mov_b32 s34, 4718592
    s_mov_b32 s35, 0x00020000
    s_mov_b32 s44, s24
    s_and_b32 s45, s25, 0xffff
    s_mov_b32 s46, 14680064
    s_mov_b32 s47, 0x00020000
    s_mul_i32 s53, s26, 7340032
    s_mul_i32 s3, s4, 7
    s_lshl_b32 s52, s7, 1
    s_add_u32 s3, s3, s52
    s_lshl_b32 s3, s3, 17
    s_add_u32 s53, s53, s3
    s_lshl_b32 s3, s27, 1
    s_add_u32 s3, s3, s6
    s_lshl_b32 s3, s3, 12
    s_add_u32 s53, s53, s3
    s_cmp_ge_u32 s5, 4
    s_cbranch_scc0 K1_PRIO_DONE
    s_setprio 1
K1_PRIO_DONE:
    s_cmp_lt_u32 s5, 4
    s_cbranch_scc1 K1_FAT
    v_subrev_u32 v32, 8192, v12
    v_subrev_u32 v33, 8192, v13
    s_add_u32 s52, s49, 0
    s_add_u32 s55, s49, 73728
    s_add_u32 m0, s59, 0
    s_nop 0
    buffer_load_dwordx4 v8, s[28:31], s52 offen lds
    s_add_u32 m0, s59, 1024
    s_nop 0
    buffer_load_dwordx4 v9, s[28:31], s52 offen lds
    s_add_u32 m0, s59, 8192
    s_nop 0
    buffer_load_dwordx4 v8, s[28:31], s55 offen lds
    s_add_u32 m0, s59, 9216
    s_nop 0
    buffer_load_dwordx4 v9, s[28:31], s55 offen lds
    s_add_u32 s52, s50, 0
    s_add_u32 s55, s50, 131072
    s_add_u32 m0, s59, 16384
    s_nop 0
    buffer_load_dwordx4 v10, s[32:35], s52 offen lds
    s_add_u32 m0, s59, 17408
    s_nop 0
    buffer_load_dwordx4 v11, s[32:35], s52 offen lds
    s_add_u32 m0, s59, 24576
    s_nop 0
    buffer_load_dwordx4 v10, s[32:35], s55 offen lds
    s_add_u32 m0, s59, 25600
    s_nop 0
    buffer_load_dwordx4 v11, s[32:35], s55 offen lds
    s_add_u32 s52, s50, 262144
    s_add_u32 s55, s50, 393216
    s_add_u32 m0, s59, 32768
    s_nop 0
    buffer_load_dwordx4 v10, s[32:35], s52 offen lds
    s_add_u32 m0, s59, 33792
    s_nop 0
    buffer_load_dwordx4 v11, s[32:35], s52 offen lds
    s_add_u32 m0, s59, 40960
    s_nop 0
    buffer_load_dwordx4 v10, s[32:35], s55 offen lds
    s_add_u32 m0, s59, 41984
    s_nop 0
    buffer_load_dwordx4 v11, s[32:35], s55 offen lds
    s_add_u32 s52, s49, 128
    s_add_u32 s55, s49, 73856
    s_add_u32 m0, s59, 49152
    s_nop 0
    buffer_load_dwordx4 v8, s[28:31], s52 offen lds
    s_add_u32 m0, s59, 50176
    s_nop 0
    buffer_load_dwordx4 v9, s[28:31], s52 offen lds
    s_add_u32 m0, s59, 57344
    s_nop 0
    buffer_load_dwordx4 v8, s[28:31], s55 offen lds
    s_add_u32 m0, s59, 58368
    s_nop 0
    buffer_load_dwordx4 v9, s[28:31], s55 offen lds
    s_add_u32 s52, s50, 524288
    s_add_u32 s55, s50, 655360
    s_add_u32 m0, s59, 65536
    s_nop 0
    buffer_load_dwordx4 v10, s[32:35], s52 offen lds
    s_add_u32 m0, s59, 66560
    s_nop 0
    buffer_load_dwordx4 v11, s[32:35], s52 offen lds
    s_add_u32 m0, s59, 73728
    s_nop 0
    buffer_load_dwordx4 v10, s[32:35], s55 offen lds
    s_add_u32 m0, s59, 74752
    s_nop 0
    buffer_load_dwordx4 v11, s[32:35], s55 offen lds
    s_add_u32 s52, s50, 786432
    s_add_u32 s55, s50, 917504
    s_add_u32 m0, s59, 81920
    s_nop 0
    buffer_load_dwordx4 v10, s[32:35], s52 offen lds
    s_add_u32 m0, s59, 82944
    s_nop 0
    buffer_load_dwordx4 v11, s[32:35], s52 offen lds
    s_add_u32 m0, s59, 90112
    s_nop 0
    buffer_load_dwordx4 v10, s[32:35], s55 offen lds
    s_add_u32 m0, s59, 91136
    s_nop 0
    buffer_load_dwordx4 v11, s[32:35], s55 offen lds
    s_add_u32 s52, s49, 256
    s_add_u32 s55, s49, 73984
    s_add_u32 m0, s59, 98304
    s_nop 0
    buffer_load_dwordx4 v8, s[28:31], s52 offen lds
    s_add_u32 m0, s59, 99328
    s_nop 0
    buffer_load_dwordx4 v9, s[28:31], s52 offen lds
    s_add_u32 m0, s59, 106496
    s_nop 0
    buffer_load_dwordx4 v8, s[28:31], s55 offen lds
    s_add_u32 m0, s59, 107520
    s_nop 0
    buffer_load_dwordx4 v9, s[28:31], s55 offen lds
    s_add_u32 s52, s50, 1048576
    s_add_u32 s55, s50, 1179648
    s_add_u32 m0, s59, 114688
    s_nop 0
    buffer_load_dwordx4 v10, s[32:35], s52 offen lds
    s_add_u32 m0, s59, 115712
    s_nop 0
    buffer_load_dwordx4 v11, s[32:35], s52 offen lds
    s_add_u32 m0, s59, 122880
    s_nop 0
    buffer_load_dwordx4 v10, s[32:35], s55 offen lds
    s_add_u32 m0, s59, 123904
    s_nop 0
    buffer_load_dwordx4 v11, s[32:35], s55 offen lds
    s_add_u32 s52, s50, 1310720
    s_add_u32 s55, s50, 1441792
    s_add_u32 m0, s59, 131072
    s_nop 0
    buffer_load_dwordx4 v10, s[32:35], s52 offen lds
    s_add_u32 m0, s59, 132096
    s_nop 0
    buffer_load_dwordx4 v11, s[32:35], s52 offen lds
    s_add_u32 m0, s59, 139264
    s_nop 0
    buffer_load_dwordx4 v10, s[32:35], s55 offen lds
    s_add_u32 m0, s59, 140288
    s_nop 0
    buffer_load_dwordx4 v11, s[32:35], s55 offen lds
    v_lshrrev_b32 v1, 2, v0
    v_lshlrev_b32 v1, 13, v1
    v_and_b32 v2, 3, v0
    v_lshl_add_u32 v1, v2, 7, v1
    s_lshl_b32 s3, s5, 4
    s_min_u32 s3, s3, 56
    s_mul_i32 s52, s4, 72
    s_add_u32 s3, s3, s52
    s_lshl_b32 s3, s3, 13
    s_add_u32 s3, s3, s50
    buffer_load_dword v4, v1, s[32:35], s3 offen
    v_lshlrev_b32 v2, 7, v0
    s_and_b32 s3, s27, 3
    s_mul_i32 s3, s3, 32256
    s_and_b32 s52, s5, 3
    s_lshl_b32 s52, s52, 13
    s_add_u32 s3, s3, s52
    s_add_u32 s3, s3, s49
    buffer_load_dword v5, v2, s[28:31], s3 offen
    s_waitcnt vmcnt(26)
    s_barrier
    s_waitcnt vmcnt(14)
    s_barrier
    s_add_u32 s52, s49, 384
    s_add_u32 s55, s49, 74112
    s_add_u32 m0, s59, 147456
    s_nop 0
    buffer_load_dwordx4 v8, s[28:31], s52 offen lds
    s_add_u32 m0, s59, 148480
    s_nop 0
    buffer_load_dwordx4 v9, s[28:31], s52 offen lds
    s_add_u32 m0, s59, 155648
    s_nop 0
    buffer_load_dwordx4 v8, s[28:31], s55 offen lds
    s_add_u32 m0, s59, 156672
    s_nop 0
    buffer_load_dwordx4 v9, s[28:31], s55 offen lds
    s_add_u32 s52, s50, 1572864
    s_add_u32 s55, s50, 1703936
    s_add_u32 m0, s59, 0
    s_nop 0
    buffer_load_dwordx4 v10, s[32:35], s52 offen lds
    s_add_u32 m0, s59, 1024
    s_nop 0
    buffer_load_dwordx4 v11, s[32:35], s52 offen lds
    s_add_u32 m0, s59, 8192
    s_nop 0
    buffer_load_dwordx4 v10, s[32:35], s55 offen lds
    s_add_u32 m0, s59, 9216
    s_nop 0
    buffer_load_dwordx4 v11, s[32:35], s55 offen lds
    s_add_u32 s52, s50, 1835008
    s_add_u32 s55, s50, 1966080
    s_add_u32 m0, s59, 16384
    s_nop 0
    buffer_load_dwordx4 v10, s[32:35], s52 offen lds
    s_add_u32 m0, s59, 17408
    s_nop 0
    buffer_load_dwordx4 v11, s[32:35], s52 offen lds
    s_add_u32 m0, s59, 24576
    s_nop 0
    buffer_load_dwordx4 v10, s[32:35], s55 offen lds
    s_add_u32 m0, s59, 25600
    s_nop 0
    buffer_load_dwordx4 v11, s[32:35], s55 offen lds
    s_waitcnt vmcnt(14)
    s_barrier
    s_add_u32 s52, s49, 512
    s_add_u32 s55, s49, 74240
    s_add_u32 m0, s59, 32768
    s_nop 0
    buffer_load_dwordx4 v8, s[28:31], s52 offen lds
    s_add_u32 m0, s59, 33792
    s_nop 0
    buffer_load_dwordx4 v9, s[28:31], s52 offen lds
    s_add_u32 m0, s59, 40960
    s_nop 0
    buffer_load_dwordx4 v8, s[28:31], s55 offen lds
    s_add_u32 m0, s59, 41984
    s_nop 0
    buffer_load_dwordx4 v9, s[28:31], s55 offen lds
    s_add_u32 s52, s50, 2097152
    s_add_u32 s55, s50, 2228224
    s_add_u32 m0, s59, 49152
    s_nop 0
    buffer_load_dwordx4 v10, s[32:35], s52 offen lds
    s_add_u32 m0, s59, 50176
    s_nop 0
    buffer_load_dwordx4 v11, s[32:35], s52 offen lds
    s_add_u32 m0, s59, 57344
    s_nop 0
    buffer_load_dwordx4 v10, s[32:35], s55 offen lds
    s_add_u32 m0, s59, 58368
    s_nop 0
    buffer_load_dwordx4 v11, s[32:35], s55 offen lds
    s_add_u32 s52, s50, 2359296
    s_add_u32 s55, s50, 2490368
    s_add_u32 m0, s59, 65536
    s_nop 0
    buffer_load_dwordx4 v10, s[32:35], s52 offen lds
    s_add_u32 m0, s59, 66560
    s_nop 0
    buffer_load_dwordx4 v11, s[32:35], s52 offen lds
    s_add_u32 m0, s59, 73728
    s_nop 0
    buffer_load_dwordx4 v10, s[32:35], s55 offen lds
    s_add_u32 m0, s59, 74752
    s_nop 0
    buffer_load_dwordx4 v11, s[32:35], s55 offen lds
    s_waitcnt vmcnt(12)
    s_barrier
    s_add_u32 s52, s49, 640
    s_add_u32 s55, s49, 74368
    s_add_u32 m0, s59, 81920
    s_nop 0
    buffer_load_dwordx4 v8, s[28:31], s52 offen lds
    s_add_u32 m0, s59, 82944
    s_nop 0
    buffer_load_dwordx4 v9, s[28:31], s52 offen lds
    s_add_u32 m0, s59, 90112
    s_nop 0
    buffer_load_dwordx4 v8, s[28:31], s55 offen lds
    s_add_u32 m0, s59, 91136
    s_nop 0
    buffer_load_dwordx4 v9, s[28:31], s55 offen lds
    s_add_u32 s52, s50, 2621440
    s_add_u32 s55, s50, 2752512
    s_add_u32 m0, s59, 98304
    s_nop 0
    buffer_load_dwordx4 v10, s[32:35], s52 offen lds
    s_add_u32 m0, s59, 99328
    s_nop 0
    buffer_load_dwordx4 v11, s[32:35], s52 offen lds
    s_add_u32 m0, s59, 106496
    s_nop 0
    buffer_load_dwordx4 v10, s[32:35], s55 offen lds
    s_add_u32 m0, s59, 107520
    s_nop 0
    buffer_load_dwordx4 v11, s[32:35], s55 offen lds
    s_add_u32 s52, s50, 2883584
    s_add_u32 s55, s50, 3014656
    s_add_u32 m0, s59, 114688
    s_nop 0
    buffer_load_dwordx4 v10, s[32:35], s52 offen lds
    s_add_u32 m0, s59, 115712
    s_nop 0
    buffer_load_dwordx4 v11, s[32:35], s52 offen lds
    s_add_u32 m0, s59, 122880
    s_nop 0
    buffer_load_dwordx4 v10, s[32:35], s55 offen lds
    s_add_u32 m0, s59, 123904
    s_nop 0
    buffer_load_dwordx4 v11, s[32:35], s55 offen lds
    s_add_u32 s52, s51, 0
    s_add_u32 m0, s59, 131072
    s_nop 0
    buffer_load_dwordx4 v32, s[36:39], s52 offen nt lds
    s_add_u32 m0, s59, 132096
    s_nop 0
    buffer_load_dwordx4 v33, s[36:39], s52 offen nt lds
    s_add_u32 m0, s59, 139264
    s_nop 0
    buffer_load_dwordx4 v12, s[36:39], s52 offen nt lds
    s_add_u32 m0, s59, 140288
    s_nop 0
    buffer_load_dwordx4 v13, s[36:39], s52 offen nt lds
    s_waitcnt vmcnt(16)
    s_barrier
    s_add_u32 s52, s49, 768
    s_add_u32 s55, s49, 74496
    s_add_u32 m0, s59, 147456
    s_nop 0
    buffer_load_dwordx4 v8, s[28:31], s52 offen lds
    s_add_u32 m0, s59, 148480
    s_nop 0
    buffer_load_dwordx4 v9, s[28:31], s52 offen lds
    s_add_u32 m0, s59, 155648
    s_nop 0
    buffer_load_dwordx4 v8, s[28:31], s55 offen lds
    s_add_u32 m0, s59, 156672
    s_nop 0
    buffer_load_dwordx4 v9, s[28:31], s55 offen lds
    s_add_u32 s52, s50, 3145728
    s_add_u32 s55, s50, 3276800
    s_add_u32 m0, s59, 0
    s_nop 0
    buffer_load_dwordx4 v10, s[32:35], s52 offen lds
    s_add_u32 m0, s59, 1024
    s_nop 0
    buffer_load_dwordx4 v11, s[32:35], s52 offen lds
    s_add_u32 m0, s59, 8192
    s_nop 0
    buffer_load_dwordx4 v10, s[32:35], s55 offen lds
    s_add_u32 m0, s59, 9216
    s_nop 0
    buffer_load_dwordx4 v11, s[32:35], s55 offen lds
    s_add_u32 s52, s50, 3407872
    s_add_u32 s55, s50, 3538944
    s_add_u32 m0, s59, 16384
    s_nop 0
    buffer_load_dwordx4 v10, s[32:35], s52 offen lds
    s_add_u32 m0, s59, 17408
    s_nop 0
    buffer_load_dwordx4 v11, s[32:35], s52 offen lds
    s_add_u32 m0, s59, 24576
    s_nop 0
    buffer_load_dwordx4 v10, s[32:35], s55 offen lds
    s_add_u32 m0, s59, 25600
    s_nop 0
    buffer_load_dwordx4 v11, s[32:35], s55 offen lds
    s_waitcnt vmcnt(16)
    s_barrier
    s_add_u32 s52, s49, 896
    s_add_u32 s55, s49, 74624
    s_add_u32 m0, s59, 32768
    s_nop 0
    buffer_load_dwordx4 v8, s[28:31], s52 offen lds
    s_add_u32 m0, s59, 33792
    s_nop 0
    buffer_load_dwordx4 v9, s[28:31], s52 offen lds
    s_add_u32 m0, s59, 40960
    s_nop 0
    buffer_load_dwordx4 v8, s[28:31], s55 offen lds
    s_add_u32 m0, s59, 41984
    s_nop 0
    buffer_load_dwordx4 v9, s[28:31], s55 offen lds
    s_add_u32 s52, s50, 3670016
    s_add_u32 s55, s50, 3801088
    s_add_u32 m0, s59, 49152
    s_nop 0
    buffer_load_dwordx4 v10, s[32:35], s52 offen lds
    s_add_u32 m0, s59, 50176
    s_nop 0
    buffer_load_dwordx4 v11, s[32:35], s52 offen lds
    s_add_u32 m0, s59, 57344
    s_nop 0
    buffer_load_dwordx4 v10, s[32:35], s55 offen lds
    s_add_u32 m0, s59, 58368
    s_nop 0
    buffer_load_dwordx4 v11, s[32:35], s55 offen lds
    s_add_u32 s52, s50, 3932160
    s_add_u32 s55, s50, 4063232
    s_add_u32 m0, s59, 65536
    s_nop 0
    buffer_load_dwordx4 v10, s[32:35], s52 offen lds
    s_add_u32 m0, s59, 66560
    s_nop 0
    buffer_load_dwordx4 v11, s[32:35], s52 offen lds
    s_add_u32 m0, s59, 73728
    s_nop 0
    buffer_load_dwordx4 v10, s[32:35], s55 offen lds
    s_add_u32 m0, s59, 74752
    s_nop 0
    buffer_load_dwordx4 v11, s[32:35], s55 offen lds
    s_waitcnt vmcnt(12)
    s_barrier
    s_add_u32 s52, s49, 1024
    s_add_u32 s55, s49, 74752
    s_add_u32 m0, s59, 81920
    s_nop 0
    buffer_load_dwordx4 v8, s[28:31], s52 offen lds
    s_add_u32 m0, s59, 82944
    s_nop 0
    buffer_load_dwordx4 v9, s[28:31], s52 offen lds
    s_add_u32 m0, s59, 90112
    s_nop 0
    buffer_load_dwordx4 v8, s[28:31], s55 offen lds
    s_add_u32 m0, s59, 91136
    s_nop 0
    buffer_load_dwordx4 v9, s[28:31], s55 offen lds
    s_add_u32 s52, s50, 4194304
    s_add_u32 s55, s50, 4325376
    s_add_u32 m0, s59, 98304
    s_nop 0
    buffer_load_dwordx4 v10, s[32:35], s52 offen lds
    s_add_u32 m0, s59, 99328
    s_nop 0
    buffer_load_dwordx4 v11, s[32:35], s52 offen lds
    s_add_u32 m0, s59, 106496
    s_nop 0
    buffer_load_dwordx4 v10, s[32:35], s55 offen lds
    s_add_u32 m0, s59, 107520
    s_nop 0
    buffer_load_dwordx4 v11, s[32:35], s55 offen lds
    s_add_u32 s52, s50, 4456448
    s_add_u32 s55, s50, 4587520
    s_add_u32 m0, s59, 114688
    s_nop 0
    buffer_load_dwordx4 v10, s[32:35], s52 offen lds
    s_add_u32 m0, s59, 115712
    s_nop 0
    buffer_load_dwordx4 v11, s[32:35], s52 offen lds
    s_add_u32 m0, s59, 122880
    s_nop 0
    buffer_load_dwordx4 v10, s[32:35], s55 offen lds
    s_add_u32 m0, s59, 123904
    s_nop 0
    buffer_load_dwordx4 v11, s[32:35], s55 offen lds
    s_waitcnt vmcnt(12)
    s_barrier
    s_add_u32 s52, s51, 16384
    s_add_u32 m0, s59, 147456
    s_nop 0
    buffer_load_dwordx4 v32, s[36:39], s52 offen nt lds
    s_add_u32 m0, s59, 148480
    s_nop 0
    buffer_load_dwordx4 v33, s[36:39], s52 offen nt lds
    s_add_u32 m0, s59, 155648
    s_nop 0
    buffer_load_dwordx4 v12, s[36:39], s52 offen nt lds
    s_add_u32 m0, s59, 156672
    s_nop 0
    buffer_load_dwordx4 v13, s[36:39], s52 offen nt lds
    s_add_u32 s52, s51, 0
    s_add_u32 m0, s59, 0
    s_nop 0
    buffer_load_dwordx4 v32, s[40:43], s52 offen nt lds
    s_add_u32 m0, s59, 1024
    s_nop 0
    buffer_load_dwordx4 v33, s[40:43], s52 offen nt lds
    s_add_u32 m0, s59, 8192
    s_nop 0
    buffer_load_dwordx4 v12, s[40:43], s52 offen nt lds
    s_add_u32 m0, s59, 9216
    s_nop 0
    buffer_load_dwordx4 v13, s[40:43], s52 offen nt lds
    s_add_u32 s52, s51, 32768
    s_add_u32 m0, s59, 16384
    s_nop 0
    buffer_load_dwordx4 v32, s[36:39], s52 offen nt lds
    s_add_u32 m0, s59, 17408
    s_nop 0
    buffer_load_dwordx4 v33, s[36:39], s52 offen nt lds
    s_add_u32 m0, s59, 24576
    s_nop 0
    buffer_load_dwordx4 v12, s[36:39], s52 offen nt lds
    s_add_u32 m0, s59, 25600
    s_nop 0
    buffer_load_dwordx4 v13, s[36:39], s52 offen nt lds
    s_waitcnt vmcnt(12)
    s_barrier
    s_add_u32 s52, s51, 16384
    s_add_u32 m0, s59, 65536
    s_nop 0
    buffer_load_dwordx4 v32, s[40:43], s52 offen nt lds
    s_add_u32 m0, s59, 66560
    s_nop 0
    buffer_load_dwordx4 v33, s[40:43], s52 offen nt lds
    s_add_u32 m0, s59, 73728
    s_nop 0
    buffer_load_dwordx4 v12, s[40:43], s52 offen nt lds
    s_add_u32 m0, s59, 74752
    s_nop 0
    buffer_load_dwordx4 v13, s[40:43], s52 offen nt lds
    s_branch K1_ATT
K1_FAT:
    s_nop 4
    v_lshlrev_b32 v8, 7, v0
    s_lshl_b32 s3, s5, 13
    v_add_u32 v8, s3, v8
    v_lshrrev_b32 v1, 2, v0
    v_lshlrev_b32 v1, 13, v1
    v_and_b32 v2, 3, v0
    v_lshl_add_u32 v1, v2, 7, v1
    s_lshl_b32 s3, s5, 4
    s_min_u32 s3, s3, 56
    s_mul_i32 s52, s4, 72
    s_add_u32 s3, s3, s52
    s_lshl_b32 s3, s3, 13
    s_add_u32 s3, s3, s50
    buffer_load_dword v4, v1, s[32:35], s3 offen
    v_lshlrev_b32 v2, 7, v0
    s_and_b32 s3, s27, 3
    s_mul_i32 s3, s3, 32256
    s_and_b32 s52, s5, 3
    s_lshl_b32 s52, s52, 13
    s_add_u32 s3, s3, s52
    s_add_u32 s3, s3, s49
    buffer_load_dword v5, v2, s[28:31], s3 offen
    s_load_dwordx2 s[16:17], s[0:1], 32
    s_load_dwordx2 s[18:19], s[0:1], 72
    s_load_dwordx2 s[20:21], s[0:1], 80
    v_lshlrev_b32 v1, 12, v0
    v_and_b32 v1, 0x1ffff, v1
    buffer_load_dword v48, v1, s[40:43], s51 offen
    buffer_load_dword v49, v1, s[36:39], s51 offen
    v_min_u32 v2, 6, v0
    v_lshlrev_b32 v2, 17, v2
    s_mul_i32 s3, s26, 7340032
    s_mul_i32 s52, s4, 917504
    s_add_u32 s3, s3, s52
    s_lshl_b32 s52, s27, 13
    s_add_u32 s3, s3, s52
    buffer_store_dword v2, v2, s[44:47], s3 offen sc1
    v_lshlrev_b32 v3, 16, v0
    s_waitcnt lgkmcnt(0)
    s_cmp_eq_u32 s26, 0
    s_cselect_b32 s60, s16, s18
    s_cselect_b32 s61, s17, s19
    s_and_b32 s61, s61, 0xffff
    s_mov_b32 s62, 4718592
    s_mov_b32 s63, 0x00020000
    s_mov_b32 s3, 524288
    buffer_load_dword v51, v3, s[60:63], 0 offen
    buffer_load_dword v52, v3, s[60:63], s3 offen
    s_mov_b32 s16, s20
    s_and_b32 s17, s21, 0xffff
    s_mov_b32 s18, 2064384
    s_mov_b32 s19, 0x00020000
    buffer_load_dword v53, v3, s[16:19], 0 offen
    v_add_u32 v40, 0, v15
    v_xor_b32 v41, 32, v40
    v_xor_b32 v42, 64, v40
    v_xor_b32 v43, 96, v40
    v_add_u32 v32, 16384, v14
    v_xor_b32 v33, 64, v32
    v_xor_b32 v34, 128, v32
    v_xor_b32 v35, 192, v32
    v_add_u32 v36, 32768, v14
    v_xor_b32 v37, 64, v36
    v_xor_b32 v38, 128, v36
    v_xor_b32 v39, 192, v36
    s_barrier
    ds_read_b128 v[240:243], v40 offset:0
    ds_read_b128 v[244:247], v40 offset:4096
    ds_read_b64_tr_b16 v[224:225], v32 offset:0
    ds_read_b64_tr_b16 v[226:227], v32 offset:2048
    ds_read_b64_tr_b16 v[228:229], v33 offset:0
    ds_read_b64_tr_b16 v[230:231], v33 offset:2048
    ds_read_b64_tr_b16 v[232:233], v34 offset:0
    ds_read_b64_tr_b16 v[234:235], v34 offset:2048
    ds_read_b64_tr_b16 v[236:237], v35 offset:0
    ds_read_b64_tr_b16 v[238:239], v35 offset:2048
    s_waitcnt lgkmcnt(0)
    v_mfma_f32_32x32x16_bf16 v[96:111], v[224:227], v[240:243], 0
    ds_read_b128 v[80:83], v41 offset:0
    ds_read_b128 v[84:87], v41 offset:4096
    v_mfma_f32_32x32x16_bf16 v[160:175], v[224:227], v[244:247], 0
    ds_read_b64_tr_b16 v[64:65], v32 offset:8192
    ds_read_b64_tr_b16 v[66:67], v32 offset:10240
    v_mfma_f32_32x32x16_bf16 v[112:127], v[228:231], v[240:243], 0
    ds_read_b64_tr_b16 v[68:69], v33 offset:8192
    ds_read_b64_tr_b16 v[70:71], v33 offset:10240
    v_mfma_f32_32x32x16_bf16 v[176:191], v[228:231], v[244:247], 0
    ds_read_b64_tr_b16 v[72:73], v34 offset:8192
    ds_read_b64_tr_b16 v[74:75], v34 offset:10240
    v_mfma_f32_32x32x16_bf16 v[128:143], v[232:235], v[240:243], 0
    ds_read_b64_tr_b16 v[76:77], v35 offset:8192
    ds_read_b64_tr_b16 v[78:79], v35 offset:10240
    v_mfma_f32_32x32x16_bf16 v[192:207], v[232:235], v[244:247], 0
    v_mfma_f32_32x32x16_bf16 v[144:159], v[236:239], v[240:243], 0
    v_mfma_f32_32x32x16_bf16 v[208:223], v[236:239], v[244:247], 0
    s_waitcnt lgkmcnt(0)
    v_mfma_f32_32x32x16_bf16 v[96:111], v[64:67], v[80:83], v[96:111]
    ds_read_b128 v[240:243], v42 offset:0
    ds_read_b128 v[244:247], v42 offset:4096
    v_mfma_f32_32x32x16_bf16 v[160:175], v[64:67], v[84:87], v[160:175]
    ds_read_b64_tr_b16 v[224:225], v36 offset:0
    ds_read_b64_tr_b16 v[226:227], v36 offset:2048
    v_mfma_f32_32x32x16_bf16 v[112:127], v[68:71], v[80:83], v[112:127]
    ds_read_b64_tr_b16 v[228:229], v37 offset:0
    ds_read_b64_tr_b16 v[230:231], v37 offset:2048
    v_mfma_f32_32x32x16_bf16 v[176:191], v[68:71], v[84:87], v[176:191]
    ds_read_b64_tr_b16 v[232:233], v38 offset:0
    ds_read_b64_tr_b16 v[234:235], v38 offset:2048
    v_mfma_f32_32x32x16_bf16 v[128:143], v[72:75], v[80:83], v[128:143]
    ds_read_b64_tr_b16 v[236:237], v39 offset:0
    ds_read_b64_tr_b16 v[238:239], v39 offset:2048
    v_mfma_f32_32x32x16_bf16 v[192:207], v[72:75], v[84:87], v[192:207]
    v_mfma_f32_32x32x16_bf16 v[144:159], v[76:79], v[80:83], v[144:159]
    v_mfma_f32_32x32x16_bf16 v[208:223], v[76:79], v[84:87], v[208:223]
    s_waitcnt lgkmcnt(0)
    v_mfma_f32_32x32x16_bf16 v[96:111], v[224:227], v[240:243], v[96:111]
    ds_read_b128 v[80:83], v43 offset:0
    ds_read_b128 v[84:87], v43 offset:4096
    v_mfma_f32_32x32x16_bf16 v[160:175], v[224:227], v[244:247], v[160:175]
    ds_read_b64_tr_b16 v[64:65], v36 offset:8192
    ds_read_b64_tr_b16 v[66:67], v36 offset:10240
    v_mfma_f32_32x32x16_bf16 v[112:127], v[228:231], v[240:243], v[112:127]
    ds_read_b64_tr_b16 v[68:69], v37 offset:8192
    ds_read_b64_tr_b16 v[70:71], v37 offset:10240
    v_mfma_f32_32x32x16_bf16 v[176:191], v[228:231], v[244:247], v[176:191]
    ds_read_b64_tr_b16 v[72:73], v38 offset:8192
    ds_read_b64_tr_b16 v[74:75], v38 offset:10240
    v_mfma_f32_32x32x16_bf16 v[128:143], v[232:235], v[240:243], v[128:143]
    ds_read_b64_tr_b16 v[76:77], v39 offset:8192
    ds_read_b64_tr_b16 v[78:79], v39 offset:10240
    v_mfma_f32_32x32x16_bf16 v[192:207], v[232:235], v[244:247], v[192:207]
    v_mfma_f32_32x32x16_bf16 v[144:159], v[236:239], v[240:243], v[144:159]
    v_mfma_f32_32x32x16_bf16 v[208:223], v[236:239], v[244:247], v[208:223]
    s_waitcnt lgkmcnt(0)
    v_mfma_f32_32x32x16_bf16 v[96:111], v[64:67], v[80:83], v[96:111]
    v_add_u32 v40, 49152, v15
    v_xor_b32 v41, 32, v40
    v_xor_b32 v42, 64, v40
    v_xor_b32 v43, 96, v40
    v_add_u32 v32, 65536, v14
    v_xor_b32 v33, 64, v32
    v_mfma_f32_32x32x16_bf16 v[160:175], v[64:67], v[84:87], v[160:175]
    v_xor_b32 v34, 128, v32
    v_xor_b32 v35, 192, v32
    v_add_u32 v36, 81920, v14
    v_xor_b32 v37, 64, v36
    v_xor_b32 v38, 128, v36
    v_xor_b32 v39, 192, v36
    s_barrier
    ds_read_b128 v[240:243], v40 offset:0
    ds_read_b128 v[244:247], v40 offset:4096
    v_mfma_f32_32x32x16_bf16 v[112:127], v[68:71], v[80:83], v[112:127]
    ds_read_b64_tr_b16 v[224:225], v32 offset:0
    ds_read_b64_tr_b16 v[226:227], v32 offset:2048
    v_mfma_f32_32x32x16_bf16 v[176:191], v[68:71], v[84:87], v[176:191]
    ds_read_b64_tr_b16 v[228:229], v33 offset:0
    ds_read_b64_tr_b16 v[230:231], v33 offset:2048
    v_mfma_f32_32x32x16_bf16 v[128:143], v[72:75], v[80:83], v[128:143]
    ds_read_b64_tr_b16 v[232:233], v34 offset:0
    ds_read_b64_tr_b16 v[234:235], v34 offset:2048
    v_mfma_f32_32x32x16_bf16 v[192:207], v[72:75], v[84:87], v[192:207]
    ds_read_b64_tr_b16 v[236:237], v35 offset:0
    ds_read_b64_tr_b16 v[238:239], v35 offset:2048
    v_mfma_f32_32x32x16_bf16 v[144:159], v[76:79], v[80:83], v[144:159]
    v_mfma_f32_32x32x16_bf16 v[208:223], v[76:79], v[84:87], v[208:223]
    s_waitcnt lgkmcnt(0)
    v_mfma_f32_32x32x16_bf16 v[96:111], v[224:227], v[240:243], v[96:111]
    ds_read_b128 v[80:83], v41 offset:0
    ds_read_b128 v[84:87], v41 offset:4096
    v_mfma_f32_32x32x16_bf16 v[160:175], v[224:227], v[244:247], v[160:175]
    ds_read_b64_tr_b16 v[64:65], v32 offset:8192
    ds_read_b64_tr_b16 v[66:67], v32 offset:10240
    v_mfma_f32_32x32x16_bf16 v[112:127], v[228:231], v[240:243], v[112:127]
    ds_read_b64_tr_b16 v[68:69], v33 offset:8192
    ds_read_b64_tr_b16 v[70:71], v33 offset:10240
    v_mfma_f32_32x32x16_bf16 v[176:191], v[228:231], v[244:247], v[176:191]
    ds_read_b64_tr_b16 v[72:73], v34 offset:8192
    ds_read_b64_tr_b16 v[74:75], v34 offset:10240
    v_mfma_f32_32x32x16_bf16 v[128:143], v[232:235], v[240:243], v[128:143]
    ds_read_b64_tr_b16 v[76:77], v35 offset:8192
    ds_read_b64_tr_b16 v[78:79], v35 offset:10240
    v_mfma_f32_32x32x16_bf16 v[192:207], v[232:235], v[244:247], v[192:207]
    v_mfma_f32_32x32x16_bf16 v[144:159], v[236:239], v[240:243], v[144:159]
    v_mfma_f32_32x32x16_bf16 v[208:223], v[236:239], v[244:247], v[208:223]
    s_waitcnt lgkmcnt(0)
    v_mfma_f32_32x32x16_bf16 v[96:111], v[64:67], v[80:83], v[96:111]
    ds_read_b128 v[240:243], v42 offset:0
    ds_read_b128 v[244:247], v42 offset:4096
    v_mfma_f32_32x32x16_bf16 v[160:175], v[64:67], v[84:87], v[160:175]
    ds_read_b64_tr_b16 v[224:225], v36 offset:0
    ds_read_b64_tr_b16 v[226:227], v36 offset:2048
    v_mfma_f32_32x32x16_bf16 v[112:127], v[68:71], v[80:83], v[112:127]
    ds_read_b64_tr_b16 v[228:229], v37 offset:0
    ds_read_b64_tr_b16 v[230:231], v37 offset:2048
    v_mfma_f32_32x32x16_bf16 v[176:191], v[68:71], v[84:87], v[176:191]
    ds_read_b64_tr_b16 v[232:233], v38 offset:0
    ds_read_b64_tr_b16 v[234:235], v38 offset:2048
    v_mfma_f32_32x32x16_bf16 v[128:143], v[72:75], v[80:83], v[128:143]
    ds_read_b64_tr_b16 v[236:237], v39 offset:0
    ds_read_b64_tr_b16 v[238:239], v39 offset:2048
    v_mfma_f32_32x32x16_bf16 v[192:207], v[72:75], v[84:87], v[192:207]
    v_mfma_f32_32x32x16_bf16 v[144:159], v[76:79], v[80:83], v[144:159]
    v_mfma_f32_32x32x16_bf16 v[208:223], v[76:79], v[84:87], v[208:223]
    s_waitcnt lgkmcnt(0)
    v_mfma_f32_32x32x16_bf16 v[96:111], v[224:227], v[240:243], v[96:111]
    ds_read_b128 v[80:83], v43 offset:0
    ds_read_b128 v[84:87], v43 offset:4096
    v_mfma_f32_32x32x16_bf16 v[160:175], v[224:227], v[244:247], v[160:175]
    ds_read_b64_tr_b16 v[64:65], v36 offset:8192
    ds_read_b64_tr_b16 v[66:67], v36 offset:10240
    v_mfma_f32_32x32x16_bf16 v[112:127], v[228:231], v[240:243], v[112:127]
    ds_read_b64_tr_b16 v[68:69], v37 offset:8192
    ds_read_b64_tr_b16 v[70:71], v37 offset:10240
    v_mfma_f32_32x32x16_bf16 v[176:191], v[228:231], v[244:247], v[176:191]
    ds_read_b64_tr_b16 v[72:73], v38 offset:8192
    ds_read_b64_tr_b16 v[74:75], v38 offset:10240
    v_mfma_f32_32x32x16_bf16 v[128:143], v[232:235], v[240:243], v[128:143]
    ds_read_b64_tr_b16 v[76:77], v39 offset:8192
    ds_read_b64_tr_b16 v[78:79], v39 offset:10240
    v_mfma_f32_32x32x16_bf16 v[192:207], v[232:235], v[244:247], v[192:207]
    v_mfma_f32_32x32x16_bf16 v[144:159], v[236:239], v[240:243], v[144:159]
    v_mfma_f32_32x32x16_bf16 v[208:223], v[236:239], v[244:247], v[208:223]
    s_waitcnt lgkmcnt(0)
    v_mfma_f32_32x32x16_bf16 v[96:111], v[64:67], v[80:83], v[96:111]
    v_add_u32 v40, 98304, v15
    v_xor_b32 v41, 32, v40
    v_xor_b32 v42, 64, v40
    v_xor_b32 v43, 96, v40
    v_add_u32 v32, 114688, v14
    v_xor_b32 v33, 64, v32
    v_mfma_f32_32x32x16_bf16 v[160:175], v[64:67], v[84:87], v[160:175]
    v_xor_b32 v34, 128, v32
    v_xor_b32 v35, 192, v32
    v_add_u32 v36, 131072, v14
    v_xor_b32 v37, 64, v36
    v_xor_b32 v38, 128, v36
    v_xor_b32 v39, 192, v36
    s_barrier
    ds_read_b128 v[240:243], v40 offset:0
    ds_read_b128 v[244:247], v40 offset:4096
    v_mfma_f32_32x32x16_bf16 v[112:127], v[68:71], v[80:83], v[112:127]
    ds_read_b64_tr_b16 v[224:225], v32 offset:0
    ds_read_b64_tr_b16 v[226:227], v32 offset:2048
    v_mfma_f32_32x32x16_bf16 v[176:191], v[68:71], v[84:87], v[176:191]
    ds_read_b64_tr_b16 v[228:229], v33 offset:0
    ds_read_b64_tr_b16 v[230:231], v33 offset:2048
    v_mfma_f32_32x32x16_bf16 v[128:143], v[72:75], v[80:83], v[128:143]
    ds_read_b64_tr_b16 v[232:233], v34 offset:0
    ds_read_b64_tr_b16 v[234:235], v34 offset:2048
    v_mfma_f32_32x32x16_bf16 v[192:207], v[72:75], v[84:87], v[192:207]
    ds_read_b64_tr_b16 v[236:237], v35 offset:0
    ds_read_b64_tr_b16 v[238:239], v35 offset:2048
    v_mfma_f32_32x32x16_bf16 v[144:159], v[76:79], v[80:83], v[144:159]
    v_mfma_f32_32x32x16_bf16 v[208:223], v[76:79], v[84:87], v[208:223]
    s_waitcnt lgkmcnt(0)
    v_mfma_f32_32x32x16_bf16 v[96:111], v[224:227], v[240:243], v[96:111]
    ds_read_b128 v[80:83], v41 offset:0
    ds_read_b128 v[84:87], v41 offset:4096
    v_mfma_f32_32x32x16_bf16 v[160:175], v[224:227], v[244:247], v[160:175]
    ds_read_b64_tr_b16 v[64:65], v32 offset:8192
    ds_read_b64_tr_b16 v[66:67], v32 offset:10240
    v_mfma_f32_32x32x16_bf16 v[112:127], v[228:231], v[240:243], v[112:127]
    ds_read_b64_tr_b16 v[68:69], v33 offset:8192
    ds_read_b64_tr_b16 v[70:71], v33 offset:10240
    v_mfma_f32_32x32x16_bf16 v[176:191], v[228:231], v[244:247], v[176:191]
    ds_read_b64_tr_b16 v[72:73], v34 offset:8192
    ds_read_b64_tr_b16 v[74:75], v34 offset:10240
    v_mfma_f32_32x32x16_bf16 v[128:143], v[232:235], v[240:243], v[128:143]
    ds_read_b64_tr_b16 v[76:77], v35 offset:8192
    ds_read_b64_tr_b16 v[78:79], v35 offset:10240
    v_mfma_f32_32x32x16_bf16 v[192:207], v[232:235], v[244:247], v[192:207]
    v_mfma_f32_32x32x16_bf16 v[144:159], v[236:239], v[240:243], v[144:159]
    v_mfma_f32_32x32x16_bf16 v[208:223], v[236:239], v[244:247], v[208:223]
    s_waitcnt lgkmcnt(0)
    v_mfma_f32_32x32x16_bf16 v[96:111], v[64:67], v[80:83], v[96:111]
    ds_read_b128 v[240:243], v42 offset:0
    ds_read_b128 v[244:247], v42 offset:4096
    v_mfma_f32_32x32x16_bf16 v[160:175], v[64:67], v[84:87], v[160:175]
    ds_read_b64_tr_b16 v[224:225], v36 offset:0
    ds_read_b64_tr_b16 v[226:227], v36 offset:2048
    v_mfma_f32_32x32x16_bf16 v[112:127], v[68:71], v[80:83], v[112:127]
    ds_read_b64_tr_b16 v[228:229], v37 offset:0
    ds_read_b64_tr_b16 v[230:231], v37 offset:2048
    v_mfma_f32_32x32x16_bf16 v[176:191], v[68:71], v[84:87], v[176:191]
    ds_read_b64_tr_b16 v[232:233], v38 offset:0
    ds_read_b64_tr_b16 v[234:235], v38 offset:2048
    v_mfma_f32_32x32x16_bf16 v[128:143], v[72:75], v[80:83], v[128:143]
    ds_read_b64_tr_b16 v[236:237], v39 offset:0
    ds_read_b64_tr_b16 v[238:239], v39 offset:2048
    v_mfma_f32_32x32x16_bf16 v[192:207], v[72:75], v[84:87], v[192:207]
    v_mfma_f32_32x32x16_bf16 v[144:159], v[76:79], v[80:83], v[144:159]
    v_mfma_f32_32x32x16_bf16 v[208:223], v[76:79], v[84:87], v[208:223]
    s_waitcnt lgkmcnt(0)
    v_mfma_f32_32x32x16_bf16 v[96:111], v[224:227], v[240:243], v[96:111]
    ds_read_b128 v[80:83], v43 offset:0
    ds_read_b128 v[84:87], v43 offset:4096
    v_mfma_f32_32x32x16_bf16 v[160:175], v[224:227], v[244:247], v[160:175]
    ds_read_b64_tr_b16 v[64:65], v36 offset:8192
    ds_read_b64_tr_b16 v[66:67], v36 offset:10240
    v_mfma_f32_32x32x16_bf16 v[112:127], v[228:231], v[240:243], v[112:127]
    ds_read_b64_tr_b16 v[68:69], v37 offset:8192
    ds_read_b64_tr_b16 v[70:71], v37 offset:10240
    v_mfma_f32_32x32x16_bf16 v[176:191], v[228:231], v[244:247], v[176:191]
    ds_read_b64_tr_b16 v[72:73], v38 offset:8192
    ds_read_b64_tr_b16 v[74:75], v38 offset:10240
    v_mfma_f32_32x32x16_bf16 v[128:143], v[232:235], v[240:243], v[128:143]
    ds_read_b64_tr_b16 v[76:77], v39 offset:8192
    ds_read_b64_tr_b16 v[78:79], v39 offset:10240
    v_mfma_f32_32x32x16_bf16 v[192:207], v[232:235], v[244:247], v[192:207]
    v_mfma_f32_32x32x16_bf16 v[144:159], v[236:239], v[240:243], v[144:159]
    v_mfma_f32_32x32x16_bf16 v[208:223], v[236:239], v[244:247], v[208:223]
    s_waitcnt lgkmcnt(0)
    v_mfma_f32_32x32x16_bf16 v[96:111], v[64:67], v[80:83], v[96:111]
    v_add_u32 v40, 147456, v15
    v_xor_b32 v41, 32, v40
    v_xor_b32 v42, 64, v40
    v_xor_b32 v43, 96, v40
    v_add_u32 v32, 0, v14
    v_xor_b32 v33, 64, v32
    v_mfma_f32_32x32x16_bf16 v[160:175], v[64:67], v[84:87], v[160:175]
    v_xor_b32 v34, 128, v32
    v_xor_b32 v35, 192, v32
    v_add_u32 v36, 16384, v14
    v_xor_b32 v37, 64, v36
    v_xor_b32 v38, 128, v36
    v_xor_b32 v39, 192, v36
    s_barrier
    ds_read_b128 v[240:243], v40 offset:0
    ds_read_b128 v[244:247], v40 offset:4096
    v_mfma_f32_32x32x16_bf16 v[112:127], v[68:71], v[80:83], v[112:127]
    ds_read_b64_tr_b16 v[224:225], v32 offset:0
    ds_read_b64_tr_b16 v[226:227], v32 offset:2048
    v_mfma_f32_32x32x16_bf16 v[176:191], v[68:71], v[84:87], v[176:191]
    ds_read_b64_tr_b16 v[228:229], v33 offset:0
    ds_read_b64_tr_b16 v[230:231], v33 offset:2048
    v_mfma_f32_32x32x16_bf16 v[128:143], v[72:75], v[80:83], v[128:143]
    ds_read_b64_tr_b16 v[232:233], v34 offset:0
    ds_read_b64_tr_b16 v[234:235], v34 offset:2048
    v_mfma_f32_32x32x16_bf16 v[192:207], v[72:75], v[84:87], v[192:207]
    ds_read_b64_tr_b16 v[236:237], v35 offset:0
    ds_read_b64_tr_b16 v[238:239], v35 offset:2048
    v_mfma_f32_32x32x16_bf16 v[144:159], v[76:79], v[80:83], v[144:159]
    v_mfma_f32_32x32x16_bf16 v[208:223], v[76:79], v[84:87], v[208:223]
    s_waitcnt lgkmcnt(0)
    v_mfma_f32_32x32x16_bf16 v[96:111], v[224:227], v[240:243], v[96:111]
    ds_read_b128 v[80:83], v41 offset:0
    ds_read_b128 v[84:87], v41 offset:4096
    v_mfma_f32_32x32x16_bf16 v[160:175], v[224:227], v[244:247], v[160:175]
    ds_read_b64_tr_b16 v[64:65], v32 offset:8192
    ds_read_b64_tr_b16 v[66:67], v32 offset:10240
    v_mfma_f32_32x32x16_bf16 v[112:127], v[228:231], v[240:243], v[112:127]
    ds_read_b64_tr_b16 v[68:69], v33 offset:8192
    ds_read_b64_tr_b16 v[70:71], v33 offset:10240
    v_mfma_f32_32x32x16_bf16 v[176:191], v[228:231], v[244:247], v[176:191]
    ds_read_b64_tr_b16 v[72:73], v34 offset:8192
    ds_read_b64_tr_b16 v[74:75], v34 offset:10240
    v_mfma_f32_32x32x16_bf16 v[128:143], v[232:235], v[240:243], v[128:143]
    ds_read_b64_tr_b16 v[76:77], v35 offset:8192
    ds_read_b64_tr_b16 v[78:79], v35 offset:10240
    v_mfma_f32_32x32x16_bf16 v[192:207], v[232:235], v[244:247], v[192:207]
    v_mfma_f32_32x32x16_bf16 v[144:159], v[236:239], v[240:243], v[144:159]
    v_mfma_f32_32x32x16_bf16 v[208:223], v[236:239], v[244:247], v[208:223]
    s_waitcnt lgkmcnt(0)
    v_mfma_f32_32x32x16_bf16 v[96:111], v[64:67], v[80:83], v[96:111]
    ds_read_b128 v[240:243], v42 offset:0
    ds_read_b128 v[244:247], v42 offset:4096
    v_mfma_f32_32x32x16_bf16 v[160:175], v[64:67], v[84:87], v[160:175]
    ds_read_b64_tr_b16 v[224:225], v36 offset:0
    ds_read_b64_tr_b16 v[226:227], v36 offset:2048
    v_mfma_f32_32x32x16_bf16 v[112:127], v[68:71], v[80:83], v[112:127]
    ds_read_b64_tr_b16 v[228:229], v37 offset:0
    ds_read_b64_tr_b16 v[230:231], v37 offset:2048
    v_mfma_f32_32x32x16_bf16 v[176:191], v[68:71], v[84:87], v[176:191]
    ds_read_b64_tr_b16 v[232:233], v38 offset:0
    ds_read_b64_tr_b16 v[234:235], v38 offset:2048
    v_mfma_f32_32x32x16_bf16 v[128:143], v[72:75], v[80:83], v[128:143]
    ds_read_b64_tr_b16 v[236:237], v39 offset:0
    ds_read_b64_tr_b16 v[238:239], v39 offset:2048
    v_mfma_f32_32x32x16_bf16 v[192:207], v[72:75], v[84:87], v[192:207]
    v_mfma_f32_32x32x16_bf16 v[144:159], v[76:79], v[80:83], v[144:159]
    v_mfma_f32_32x32x16_bf16 v[208:223], v[76:79], v[84:87], v[208:223]
    s_waitcnt lgkmcnt(0)
    v_mfma_f32_32x32x16_bf16 v[96:111], v[224:227], v[240:243], v[96:111]
    ds_read_b128 v[80:83], v43 offset:0
    ds_read_b128 v[84:87], v43 offset:4096
    v_mfma_f32_32x32x16_bf16 v[160:175], v[224:227], v[244:247], v[160:175]
    ds_read_b64_tr_b16 v[64:65], v36 offset:8192
    ds_read_b64_tr_b16 v[66:67], v36 offset:10240
    v_mfma_f32_32x32x16_bf16 v[112:127], v[228:231], v[240:243], v[112:127]
    ds_read_b64_tr_b16 v[68:69], v37 offset:8192
    ds_read_b64_tr_b16 v[70:71], v37 offset:10240
    v_mfma_f32_32x32x16_bf16 v[176:191], v[228:231], v[244:247], v[176:191]
    ds_read_b64_tr_b16 v[72:73], v38 offset:8192
    ds_read_b64_tr_b16 v[74:75], v38 offset:10240
    v_mfma_f32_32x32x16_bf16 v[128:143], v[232:235], v[240:243], v[128:143]
    ds_read_b64_tr_b16 v[76:77], v39 offset:8192
    ds_read_b64_tr_b16 v[78:79], v39 offset:10240
    v_mfma_f32_32x32x16_bf16 v[192:207], v[232:235], v[244:247], v[192:207]
    v_mfma_f32_32x32x16_bf16 v[144:159], v[236:239], v[240:243], v[144:159]
    v_mfma_f32_32x32x16_bf16 v[208:223], v[236:239], v[244:247], v[208:223]
    s_waitcnt lgkmcnt(0)
    v_mfma_f32_32x32x16_bf16 v[96:111], v[64:67], v[80:83], v[96:111]
    v_add_u32 v40, 32768, v15
    v_xor_b32 v41, 32, v40
    v_xor_b32 v42, 64, v40
    v_xor_b32 v43, 96, v40
    v_add_u32 v32, 49152, v14
    v_xor_b32 v33, 64, v32
    v_mfma_f32_32x32x16_bf16 v[160:175], v[64:67], v[84:87], v[160:175]
    v_xor_b32 v34, 128, v32
    v_xor_b32 v35, 192, v32
    v_add_u32 v36, 65536, v14
    v_xor_b32 v37, 64, v36
    v_xor_b32 v38, 128, v36
    v_xor_b32 v39, 192, v36
    s_barrier
    ds_read_b128 v[240:243], v40 offset:0
    ds_read_b128 v[244:247], v40 offset:4096
    v_mfma_f32_32x32x16_bf16 v[112:127], v[68:71], v[80:83], v[112:127]
    ds_read_b64_tr_b16 v[224:225], v32 offset:0
    ds_read_b64_tr_b16 v[226:227], v32 offset:2048
    v_mfma_f32_32x32x16_bf16 v[176:191], v[68:71], v[84:87], v[176:191]
    ds_read_b64_tr_b16 v[228:229], v33 offset:0
    ds_read_b64_tr_b16 v[230:231], v33 offset:2048
    v_mfma_f32_32x32x16_bf16 v[128:143], v[72:75], v[80:83], v[128:143]
    ds_read_b64_tr_b16 v[232:233], v34 offset:0
    ds_read_b64_tr_b16 v[234:235], v34 offset:2048
    v_mfma_f32_32x32x16_bf16 v[192:207], v[72:75], v[84:87], v[192:207]
    ds_read_b64_tr_b16 v[236:237], v35 offset:0
    ds_read_b64_tr_b16 v[238:239], v35 offset:2048
    v_mfma_f32_32x32x16_bf16 v[144:159], v[76:79], v[80:83], v[144:159]
    v_mfma_f32_32x32x16_bf16 v[208:223], v[76:79], v[84:87], v[208:223]
    s_waitcnt lgkmcnt(0)
    v_mfma_f32_32x32x16_bf16 v[96:111], v[224:227], v[240:243], v[96:111]
    ds_read_b128 v[80:83], v41 offset:0
    ds_read_b128 v[84:87], v41 offset:4096
    v_mfma_f32_32x32x16_bf16 v[160:175], v[224:227], v[244:247], v[160:175]
    ds_read_b64_tr_b16 v[64:65], v32 offset:8192
    ds_read_b64_tr_b16 v[66:67], v32 offset:10240
    v_mfma_f32_32x32x16_bf16 v[112:127], v[228:231], v[240:243], v[112:127]
    ds_read_b64_tr_b16 v[68:69], v33 offset:8192
    ds_read_b64_tr_b16 v[70:71], v33 offset:10240
    v_mfma_f32_32x32x16_bf16 v[176:191], v[228:231], v[244:247], v[176:191]
    ds_read_b64_tr_b16 v[72:73], v34 offset:8192
    ds_read_b64_tr_b16 v[74:75], v34 offset:10240
    v_mfma_f32_32x32x16_bf16 v[128:143], v[232:235], v[240:243], v[128:143]
    ds_read_b64_tr_b16 v[76:77], v35 offset:8192
    ds_read_b64_tr_b16 v[78:79], v35 offset:10240
    v_mfma_f32_32x32x16_bf16 v[192:207], v[232:235], v[244:247], v[192:207]
    v_mfma_f32_32x32x16_bf16 v[144:159], v[236:239], v[240:243], v[144:159]
    v_mfma_f32_32x32x16_bf16 v[208:223], v[236:239], v[244:247], v[208:223]
    s_waitcnt lgkmcnt(0)
    v_mfma_f32_32x32x16_bf16 v[96:111], v[64:67], v[80:83], v[96:111]
    ds_read_b128 v[240:243], v42 offset:0
    ds_read_b128 v[244:247], v42 offset:4096
    v_mfma_f32_32x32x16_bf16 v[160:175], v[64:67], v[84:87], v[160:175]
    ds_read_b64_tr_b16 v[224:225], v36 offset:0
    ds_read_b64_tr_b16 v[226:227], v36 offset:2048
    v_mfma_f32_32x32x16_bf16 v[112:127], v[68:71], v[80:83], v[112:127]
    ds_read_b64_tr_b16 v[228:229], v37 offset:0
    ds_read_b64_tr_b16 v[230:231], v37 offset:2048
    v_mfma_f32_32x32x16_bf16 v[176:191], v[68:71], v[84:87], v[176:191]
    ds_read_b64_tr_b16 v[232:233], v38 offset:0
    ds_read_b64_tr_b16 v[234:235], v38 offset:2048
    v_mfma_f32_32x32x16_bf16 v[128:143], v[72:75], v[80:83], v[128:143]
    ds_read_b64_tr_b16 v[236:237], v39 offset:0
    ds_read_b64_tr_b16 v[238:239], v39 offset:2048
    v_mfma_f32_32x32x16_bf16 v[192:207], v[72:75], v[84:87], v[192:207]
    v_mfma_f32_32x32x16_bf16 v[144:159], v[76:79], v[80:83], v[144:159]
    v_mfma_f32_32x32x16_bf16 v[208:223], v[76:79], v[84:87], v[208:223]
    s_waitcnt lgkmcnt(0)
    v_mfma_f32_32x32x16_bf16 v[96:111], v[224:227], v[240:243], v[96:111]
    ds_read_b128 v[80:83], v43 offset:0
    ds_read_b128 v[84:87], v43 offset:4096
    v_mfma_f32_32x32x16_bf16 v[160:175], v[224:227], v[244:247], v[160:175]
    ds_read_b64_tr_b16 v[64:65], v36 offset:8192
    ds_read_b64_tr_b16 v[66:67], v36 offset:10240
    v_mfma_f32_32x32x16_bf16 v[112:127], v[228:231], v[240:243], v[112:127]
    ds_read_b64_tr_b16 v[68:69], v37 offset:8192
    ds_read_b64_tr_b16 v[70:71], v37 offset:10240
    v_mfma_f32_32x32x16_bf16 v[176:191], v[228:231], v[244:247], v[176:191]
    ds_read_b64_tr_b16 v[72:73], v38 offset:8192
    ds_read_b64_tr_b16 v[74:75], v38 offset:10240
    v_mfma_f32_32x32x16_bf16 v[128:143], v[232:235], v[240:243], v[128:143]
    ds_read_b64_tr_b16 v[76:77], v39 offset:8192
    ds_read_b64_tr_b16 v[78:79], v39 offset:10240
    v_mfma_f32_32x32x16_bf16 v[192:207], v[232:235], v[244:247], v[192:207]
    v_mfma_f32_32x32x16_bf16 v[144:159], v[236:239], v[240:243], v[144:159]
    v_mfma_f32_32x32x16_bf16 v[208:223], v[236:239], v[244:247], v[208:223]
    s_waitcnt lgkmcnt(0)
    v_mfma_f32_32x32x16_bf16 v[96:111], v[64:67], v[80:83], v[96:111]
    v_add_u32 v40, 81920, v15
    v_xor_b32 v41, 32, v40
    v_xor_b32 v42, 64, v40
    v_xor_b32 v43, 96, v40
    v_add_u32 v32, 98304, v14
    v_xor_b32 v33, 64, v32
    v_mfma_f32_32x32x16_bf16 v[160:175], v[64:67], v[84:87], v[160:175]
    v_xor_b32 v34, 128, v32
    v_xor_b32 v35, 192, v32
    v_add_u32 v36, 114688, v14
    v_xor_b32 v37, 64, v36
    v_xor_b32 v38, 128, v36
    v_xor_b32 v39, 192, v36
    s_barrier
    ds_read_b128 v[240:243], v40 offset:0
    ds_read_b128 v[244:247], v40 offset:4096
    v_mfma_f32_32x32x16_bf16 v[112:127], v[68:71], v[80:83], v[112:127]
    ds_read_b64_tr_b16 v[224:225], v32 offset:0
    ds_read_b64_tr_b16 v[226:227], v32 offset:2048
    v_mfma_f32_32x32x16_bf16 v[176:191], v[68:71], v[84:87], v[176:191]
    ds_read_b64_tr_b16 v[228:229], v33 offset:0
    ds_read_b64_tr_b16 v[230:231], v33 offset:2048
    v_mfma_f32_32x32x16_bf16 v[128:143], v[72:75], v[80:83], v[128:143]
    ds_read_b64_tr_b16 v[232:233], v34 offset:0
    ds_read_b64_tr_b16 v[234:235], v34 offset:2048
    v_mfma_f32_32x32x16_bf16 v[192:207], v[72:75], v[84:87], v[192:207]
    ds_read_b64_tr_b16 v[236:237], v35 offset:0
    ds_read_b64_tr_b16 v[238:239], v35 offset:2048
    v_mfma_f32_32x32x16_bf16 v[144:159], v[76:79], v[80:83], v[144:159]
    v_mfma_f32_32x32x16_bf16 v[208:223], v[76:79], v[84:87], v[208:223]
    s_waitcnt lgkmcnt(0)
    v_mfma_f32_32x32x16_bf16 v[96:111], v[224:227], v[240:243], v[96:111]
    ds_read_b128 v[80:83], v41 offset:0
    ds_read_b128 v[84:87], v41 offset:4096
    v_mfma_f32_32x32x16_bf16 v[160:175], v[224:227], v[244:247], v[160:175]
    ds_read_b64_tr_b16 v[64:65], v32 offset:8192
    ds_read_b64_tr_b16 v[66:67], v32 offset:10240
    v_mfma_f32_32x32x16_bf16 v[112:127], v[228:231], v[240:243], v[112:127]
    ds_read_b64_tr_b16 v[68:69], v33 offset:8192
    ds_read_b64_tr_b16 v[70:71], v33 offset:10240
    v_mfma_f32_32x32x16_bf16 v[176:191], v[228:231], v[244:247], v[176:191]
    ds_read_b64_tr_b16 v[72:73], v34 offset:8192
    ds_read_b64_tr_b16 v[74:75], v34 offset:10240
    v_mfma_f32_32x32x16_bf16 v[128:143], v[232:235], v[240:243], v[128:143]
    ds_read_b64_tr_b16 v[76:77], v35 offset:8192
    ds_read_b64_tr_b16 v[78:79], v35 offset:10240
    v_mfma_f32_32x32x16_bf16 v[192:207], v[232:235], v[244:247], v[192:207]
    v_mfma_f32_32x32x16_bf16 v[144:159], v[236:239], v[240:243], v[144:159]
    v_mfma_f32_32x32x16_bf16 v[208:223], v[236:239], v[244:247], v[208:223]
    s_waitcnt lgkmcnt(0)
    v_mfma_f32_32x32x16_bf16 v[96:111], v[64:67], v[80:83], v[96:111]
    ds_read_b128 v[240:243], v42 offset:0
    ds_read_b128 v[244:247], v42 offset:4096
    v_mfma_f32_32x32x16_bf16 v[160:175], v[64:67], v[84:87], v[160:175]
    ds_read_b64_tr_b16 v[224:225], v36 offset:0
    ds_read_b64_tr_b16 v[226:227], v36 offset:2048
    v_mfma_f32_32x32x16_bf16 v[112:127], v[68:71], v[80:83], v[112:127]
    ds_read_b64_tr_b16 v[228:229], v37 offset:0
    ds_read_b64_tr_b16 v[230:231], v37 offset:2048
    v_mfma_f32_32x32x16_bf16 v[176:191], v[68:71], v[84:87], v[176:191]
    ds_read_b64_tr_b16 v[232:233], v38 offset:0
    ds_read_b64_tr_b16 v[234:235], v38 offset:2048
    v_mfma_f32_32x32x16_bf16 v[128:143], v[72:75], v[80:83], v[128:143]
    ds_read_b64_tr_b16 v[236:237], v39 offset:0
    ds_read_b64_tr_b16 v[238:239], v39 offset:2048
    v_mfma_f32_32x32x16_bf16 v[192:207], v[72:75], v[84:87], v[192:207]
    v_mfma_f32_32x32x16_bf16 v[144:159], v[76:79], v[80:83], v[144:159]
    v_mfma_f32_32x32x16_bf16 v[208:223], v[76:79], v[84:87], v[208:223]
    s_waitcnt lgkmcnt(0)
    v_mfma_f32_32x32x16_bf16 v[96:111], v[224:227], v[240:243], v[96:111]
    ds_read_b128 v[80:83], v43 offset:0
    ds_read_b128 v[84:87], v43 offset:4096
    v_mfma_f32_32x32x16_bf16 v[160:175], v[224:227], v[244:247], v[160:175]
    ds_read_b64_tr_b16 v[64:65], v36 offset:8192
    ds_read_b64_tr_b16 v[66:67], v36 offset:10240
    v_mfma_f32_32x32x16_bf16 v[112:127], v[228:231], v[240:243], v[112:127]
    ds_read_b64_tr_b16 v[68:69], v37 offset:8192
    ds_read_b64_tr_b16 v[70:71], v37 offset:10240
    v_mfma_f32_32x32x16_bf16 v[176:191], v[228:231], v[244:247], v[176:191]
    ds_read_b64_tr_b16 v[72:73], v38 offset:8192
    ds_read_b64_tr_b16 v[74:75], v38 offset:10240
    v_mfma_f32_32x32x16_bf16 v[128:143], v[232:235], v[240:243], v[128:143]
    ds_read_b64_tr_b16 v[76:77], v39 offset:8192
    ds_read_b64_tr_b16 v[78:79], v39 offset:10240
    v_mfma_f32_32x32x16_bf16 v[192:207], v[232:235], v[244:247], v[192:207]
    v_mfma_f32_32x32x16_bf16 v[144:159], v[236:239], v[240:243], v[144:159]
    v_mfma_f32_32x32x16_bf16 v[208:223], v[236:239], v[244:247], v[208:223]
    s_waitcnt lgkmcnt(0)
    v_mfma_f32_32x32x16_bf16 v[96:111], v[64:67], v[80:83], v[96:111]
    v_add_u32 v40, 147456, v15
    v_xor_b32 v41, 32, v40
    v_xor_b32 v42, 64, v40
    v_xor_b32 v43, 96, v40
    v_add_u32 v32, 0, v14
    v_xor_b32 v33, 64, v32
    v_mfma_f32_32x32x16_bf16 v[160:175], v[64:67], v[84:87], v[160:175]
    v_xor_b32 v34, 128, v32
    v_xor_b32 v35, 192, v32
    v_add_u32 v36, 16384, v14
    v_xor_b32 v37, 64, v36
    v_xor_b32 v38, 128, v36
    v_xor_b32 v39, 192, v36
    s_barrier
    ds_read_b128 v[240:243], v40 offset:0
    ds_read_b128 v[244:247], v40 offset:4096
    v_mfma_f32_32x32x16_bf16 v[112:127], v[68:71], v[80:83], v[112:127]
    ds_read_b64_tr_b16 v[224:225], v32 offset:0
    ds_read_b64_tr_b16 v[226:227], v32 offset:2048
    v_mfma_f32_32x32x16_bf16 v[176:191], v[68:71], v[84:87], v[176:191]
    ds_read_b64_tr_b16 v[228:229], v33 offset:0
    ds_read_b64_tr_b16 v[230:231], v33 offset:2048
    v_mfma_f32_32x32x16_bf16 v[128:143], v[72:75], v[80:83], v[128:143]
    ds_read_b64_tr_b16 v[232:233], v34 offset:0
    ds_read_b64_tr_b16 v[234:235], v34 offset:2048
    v_mfma_f32_32x32x16_bf16 v[192:207], v[72:75], v[84:87], v[192:207]
    ds_read_b64_tr_b16 v[236:237], v35 offset:0
    ds_read_b64_tr_b16 v[238:239], v35 offset:2048
    v_mfma_f32_32x32x16_bf16 v[144:159], v[76:79], v[80:83], v[144:159]
    v_mfma_f32_32x32x16_bf16 v[208:223], v[76:79], v[84:87], v[208:223]
    s_waitcnt lgkmcnt(0)
    v_mfma_f32_32x32x16_bf16 v[96:111], v[224:227], v[240:243], v[96:111]
    ds_read_b128 v[80:83], v41 offset:0
    ds_read_b128 v[84:87], v41 offset:4096
    v_mfma_f32_32x32x16_bf16 v[160:175], v[224:227], v[244:247], v[160:175]
    ds_read_b64_tr_b16 v[64:65], v32 offset:8192
    ds_read_b64_tr_b16 v[66:67], v32 offset:10240
    v_mfma_f32_32x32x16_bf16 v[112:127], v[228:231], v[240:243], v[112:127]
    ds_read_b64_tr_b16 v[68:69], v33 offset:8192
    ds_read_b64_tr_b16 v[70:71], v33 offset:10240
    v_mfma_f32_32x32x16_bf16 v[176:191], v[228:231], v[244:247], v[176:191]
    ds_read_b64_tr_b16 v[72:73], v34 offset:8192
    ds_read_b64_tr_b16 v[74:75], v34 offset:10240
    v_mfma_f32_32x32x16_bf16 v[128:143], v[232:235], v[240:243], v[128:143]
    ds_read_b64_tr_b16 v[76:77], v35 offset:8192
    ds_read_b64_tr_b16 v[78:79], v35 offset:10240
    v_mfma_f32_32x32x16_bf16 v[192:207], v[232:235], v[244:247], v[192:207]
    v_mfma_f32_32x32x16_bf16 v[144:159], v[236:239], v[240:243], v[144:159]
    v_mfma_f32_32x32x16_bf16 v[208:223], v[236:239], v[244:247], v[208:223]
    s_waitcnt lgkmcnt(0)
    v_mfma_f32_32x32x16_bf16 v[96:111], v[64:67], v[80:83], v[96:111]
    ds_read_b128 v[240:243], v42 offset:0
    ds_read_b128 v[244:247], v42 offset:4096
    v_mfma_f32_32x32x16_bf16 v[160:175], v[64:67], v[84:87], v[160:175]
    ds_read_b64_tr_b16 v[224:225], v36 offset:0
    ds_read_b64_tr_b16 v[226:227], v36 offset:2048
    v_mfma_f32_32x32x16_bf16 v[112:127], v[68:71], v[80:83], v[112:127]
    ds_read_b64_tr_b16 v[228:229], v37 offset:0
    ds_read_b64_tr_b16 v[230:231], v37 offset:2048
    v_mfma_f32_32x32x16_bf16 v[176:191], v[68:71], v[84:87], v[176:191]
    ds_read_b64_tr_b16 v[232:233], v38 offset:0
    ds_read_b64_tr_b16 v[234:235], v38 offset:2048
    v_mfma_f32_32x32x16_bf16 v[128:143], v[72:75], v[80:83], v[128:143]
    ds_read_b64_tr_b16 v[236:237], v39 offset:0
    ds_read_b64_tr_b16 v[238:239], v39 offset:2048
    v_mfma_f32_32x32x16_bf16 v[192:207], v[72:75], v[84:87], v[192:207]
    v_mfma_f32_32x32x16_bf16 v[144:159], v[76:79], v[80:83], v[144:159]
    v_mfma_f32_32x32x16_bf16 v[208:223], v[76:79], v[84:87], v[208:223]
    s_waitcnt lgkmcnt(0)
    v_mfma_f32_32x32x16_bf16 v[96:111], v[224:227], v[240:243], v[96:111]
    ds_read_b128 v[80:83], v43 offset:0
    ds_read_b128 v[84:87], v43 offset:4096
    v_mfma_f32_32x32x16_bf16 v[160:175], v[224:227], v[244:247], v[160:175]
    ds_read_b64_tr_b16 v[64:65], v36 offset:8192
    ds_read_b64_tr_b16 v[66:67], v36 offset:10240
    v_mfma_f32_32x32x16_bf16 v[112:127], v[228:231], v[240:243], v[112:127]
    ds_read_b64_tr_b16 v[68:69], v37 offset:8192
    ds_read_b64_tr_b16 v[70:71], v37 offset:10240
    v_mfma_f32_32x32x16_bf16 v[176:191], v[228:231], v[244:247], v[176:191]
    ds_read_b64_tr_b16 v[72:73], v38 offset:8192
    ds_read_b64_tr_b16 v[74:75], v38 offset:10240
    v_mfma_f32_32x32x16_bf16 v[128:143], v[232:235], v[240:243], v[128:143]
    ds_read_b64_tr_b16 v[76:77], v39 offset:8192
    ds_read_b64_tr_b16 v[78:79], v39 offset:10240
    v_mfma_f32_32x32x16_bf16 v[192:207], v[232:235], v[244:247], v[192:207]
    v_mfma_f32_32x32x16_bf16 v[144:159], v[236:239], v[240:243], v[144:159]
    v_mfma_f32_32x32x16_bf16 v[208:223], v[236:239], v[244:247], v[208:223]
    s_waitcnt lgkmcnt(0)
    v_mfma_f32_32x32x16_bf16 v[96:111], v[64:67], v[80:83], v[96:111]
    v_add_u32 v40, 32768, v15
    v_xor_b32 v41, 32, v40
    v_xor_b32 v42, 64, v40
    v_xor_b32 v43, 96, v40
    v_add_u32 v32, 49152, v14
    v_xor_b32 v33, 64, v32
    v_mfma_f32_32x32x16_bf16 v[160:175], v[64:67], v[84:87], v[160:175]
    v_xor_b32 v34, 128, v32
    v_xor_b32 v35, 192, v32
    v_add_u32 v36, 65536, v14
    v_xor_b32 v37, 64, v36
    v_xor_b32 v38, 128, v36
    v_xor_b32 v39, 192, v36
    s_barrier
    ds_read_b128 v[240:243], v40 offset:0
    ds_read_b128 v[244:247], v40 offset:4096
    v_mfma_f32_32x32x16_bf16 v[112:127], v[68:71], v[80:83], v[112:127]
    ds_read_b64_tr_b16 v[224:225], v32 offset:0
    ds_read_b64_tr_b16 v[226:227], v32 offset:2048
    v_mfma_f32_32x32x16_bf16 v[176:191], v[68:71], v[84:87], v[176:191]
    ds_read_b64_tr_b16 v[228:229], v33 offset:0
    ds_read_b64_tr_b16 v[230:231], v33 offset:2048
    v_mfma_f32_32x32x16_bf16 v[128:143], v[72:75], v[80:83], v[128:143]
    ds_read_b64_tr_b16 v[232:233], v34 offset:0
    ds_read_b64_tr_b16 v[234:235], v34 offset:2048
    v_mfma_f32_32x32x16_bf16 v[192:207], v[72:75], v[84:87], v[192:207]
    ds_read_b64_tr_b16 v[236:237], v35 offset:0
    ds_read_b64_tr_b16 v[238:239], v35 offset:2048
    v_mfma_f32_32x32x16_bf16 v[144:159], v[76:79], v[80:83], v[144:159]
    v_mfma_f32_32x32x16_bf16 v[208:223], v[76:79], v[84:87], v[208:223]
    s_waitcnt lgkmcnt(0)
    v_mfma_f32_32x32x16_bf16 v[96:111], v[224:227], v[240:243], v[96:111]
    ds_read_b128 v[80:83], v41 offset:0
    ds_read_b128 v[84:87], v41 offset:4096
    v_mfma_f32_32x32x16_bf16 v[160:175], v[224:227], v[244:247], v[160:175]
    ds_read_b64_tr_b16 v[64:65], v32 offset:8192
    ds_read_b64_tr_b16 v[66:67], v32 offset:10240
    v_mfma_f32_32x32x16_bf16 v[112:127], v[228:231], v[240:243], v[112:127]
    ds_read_b64_tr_b16 v[68:69], v33 offset:8192
    ds_read_b64_tr_b16 v[70:71], v33 offset:10240
    v_mfma_f32_32x32x16_bf16 v[176:191], v[228:231], v[244:247], v[176:191]
    ds_read_b64_tr_b16 v[72:73], v34 offset:8192
    ds_read_b64_tr_b16 v[74:75], v34 offset:10240
    v_mfma_f32_32x32x16_bf16 v[128:143], v[232:235], v[240:243], v[128:143]
    ds_read_b64_tr_b16 v[76:77], v35 offset:8192
    ds_read_b64_tr_b16 v[78:79], v35 offset:10240
    v_mfma_f32_32x32x16_bf16 v[192:207], v[232:235], v[244:247], v[192:207]
    v_mfma_f32_32x32x16_bf16 v[144:159], v[236:239], v[240:243], v[144:159]
    v_mfma_f32_32x32x16_bf16 v[208:223], v[236:239], v[244:247], v[208:223]
    s_waitcnt lgkmcnt(0)
    v_mfma_f32_32x32x16_bf16 v[96:111], v[64:67], v[80:83], v[96:111]
    ds_read_b128 v[240:243], v42 offset:0
    ds_read_b128 v[244:247], v42 offset:4096
    v_mfma_f32_32x32x16_bf16 v[160:175], v[64:67], v[84:87], v[160:175]
    ds_read_b64_tr_b16 v[224:225], v36 offset:0
    ds_read_b64_tr_b16 v[226:227], v36 offset:2048
    v_mfma_f32_32x32x16_bf16 v[112:127], v[68:71], v[80:83], v[112:127]
    ds_read_b64_tr_b16 v[228:229], v37 offset:0
    ds_read_b64_tr_b16 v[230:231], v37 offset:2048
    v_mfma_f32_32x32x16_bf16 v[176:191], v[68:71], v[84:87], v[176:191]
    ds_read_b64_tr_b16 v[232:233], v38 offset:0
    ds_read_b64_tr_b16 v[234:235], v38 offset:2048
    v_mfma_f32_32x32x16_bf16 v[128:143], v[72:75], v[80:83], v[128:143]
    ds_read_b64_tr_b16 v[236:237], v39 offset:0
    ds_read_b64_tr_b16 v[238:239], v39 offset:2048
    v_mfma_f32_32x32x16_bf16 v[192:207], v[72:75], v[84:87], v[192:207]
    v_mfma_f32_32x32x16_bf16 v[144:159], v[76:79], v[80:83], v[144:159]
    v_mfma_f32_32x32x16_bf16 v[208:223], v[76:79], v[84:87], v[208:223]
    s_waitcnt lgkmcnt(0)
    v_mfma_f32_32x32x16_bf16 v[96:111], v[224:227], v[240:243], v[96:111]
    ds_read_b128 v[80:83], v43 offset:0
    ds_read_b128 v[84:87], v43 offset:4096
    v_mfma_f32_32x32x16_bf16 v[160:175], v[224:227], v[244:247], v[160:175]
    ds_read_b64_tr_b16 v[64:65], v36 offset:8192
    ds_read_b64_tr_b16 v[66:67], v36 offset:10240
    v_mfma_f32_32x32x16_bf16 v[112:127], v[228:231], v[240:243], v[112:127]
    ds_read_b64_tr_b16 v[68:69], v37 offset:8192
    ds_read_b64_tr_b16 v[70:71], v37 offset:10240
    v_mfma_f32_32x32x16_bf16 v[176:191], v[228:231], v[244:247], v[176:191]
    ds_read_b64_tr_b16 v[72:73], v38 offset:8192
    ds_read_b64_tr_b16 v[74:75], v38 offset:10240
    v_mfma_f32_32x32x16_bf16 v[128:143], v[232:235], v[240:243], v[128:143]
    ds_read_b64_tr_b16 v[76:77], v39 offset:8192
    ds_read_b64_tr_b16 v[78:79], v39 offset:10240
    v_mfma_f32_32x32x16_bf16 v[192:207], v[232:235], v[244:247], v[192:207]
    v_mfma_f32_32x32x16_bf16 v[144:159], v[236:239], v[240:243], v[144:159]
    v_mfma_f32_32x32x16_bf16 v[208:223], v[236:239], v[244:247], v[208:223]
    s_waitcnt lgkmcnt(0)
    v_mfma_f32_32x32x16_bf16 v[96:111], v[64:67], v[80:83], v[96:111]
    v_add_u32 v40, 81920, v15
    v_xor_b32 v41, 32, v40
    v_xor_b32 v42, 64, v40
    v_xor_b32 v43, 96, v40
    v_add_u32 v32, 98304, v14
    v_xor_b32 v33, 64, v32
    v_mfma_f32_32x32x16_bf16 v[160:175], v[64:67], v[84:87], v[160:175]
    v_xor_b32 v34, 128, v32
    v_xor_b32 v35, 192, v32
    v_add_u32 v36, 114688, v14
    v_xor_b32 v37, 64, v36
    v_xor_b32 v38, 128, v36
    v_xor_b32 v39, 192, v36
    s_barrier
    ds_read_b128 v[240:243], v40 offset:0
    ds_read_b128 v[244:247], v40 offset:4096
    v_mfma_f32_32x32x16_bf16 v[112:127], v[68:71], v[80:83], v[112:127]
    ds_read_b64_tr_b16 v[224:225], v32 offset:0
    ds_read_b64_tr_b16 v[226:227], v32 offset:2048
    v_mfma_f32_32x32x16_bf16 v[176:191], v[68:71], v[84:87], v[176:191]
    ds_read_b64_tr_b16 v[228:229], v33 offset:0
    ds_read_b64_tr_b16 v[230:231], v33 offset:2048
    v_mfma_f32_32x32x16_bf16 v[128:143], v[72:75], v[80:83], v[128:143]
    ds_read_b64_tr_b16 v[232:233], v34 offset:0
    ds_read_b64_tr_b16 v[234:235], v34 offset:2048
    v_mfma_f32_32x32x16_bf16 v[192:207], v[72:75], v[84:87], v[192:207]
    ds_read_b64_tr_b16 v[236:237], v35 offset:0
    ds_read_b64_tr_b16 v[238:239], v35 offset:2048
    v_mfma_f32_32x32x16_bf16 v[144:159], v[76:79], v[80:83], v[144:159]
    v_mfma_f32_32x32x16_bf16 v[208:223], v[76:79], v[84:87], v[208:223]
    s_waitcnt lgkmcnt(0)
    v_mfma_f32_32x32x16_bf16 v[96:111], v[224:227], v[240:243], v[96:111]
    ds_read_b128 v[80:83], v41 offset:0
    ds_read_b128 v[84:87], v41 offset:4096
    v_mfma_f32_32x32x16_bf16 v[160:175], v[224:227], v[244:247], v[160:175]
    ds_read_b64_tr_b16 v[64:65], v32 offset:8192
    ds_read_b64_tr_b16 v[66:67], v32 offset:10240
    v_mfma_f32_32x32x16_bf16 v[112:127], v[228:231], v[240:243], v[112:127]
    ds_read_b64_tr_b16 v[68:69], v33 offset:8192
    ds_read_b64_tr_b16 v[70:71], v33 offset:10240
    v_mfma_f32_32x32x16_bf16 v[176:191], v[228:231], v[244:247], v[176:191]
    ds_read_b64_tr_b16 v[72:73], v34 offset:8192
    ds_read_b64_tr_b16 v[74:75], v34 offset:10240
    v_mfma_f32_32x32x16_bf16 v[128:143], v[232:235], v[240:243], v[128:143]
    ds_read_b64_tr_b16 v[76:77], v35 offset:8192
    ds_read_b64_tr_b16 v[78:79], v35 offset:10240
    v_mfma_f32_32x32x16_bf16 v[192:207], v[232:235], v[244:247], v[192:207]
    v_mfma_f32_32x32x16_bf16 v[144:159], v[236:239], v[240:243], v[144:159]
    v_mfma_f32_32x32x16_bf16 v[208:223], v[236:239], v[244:247], v[208:223]
    s_waitcnt lgkmcnt(0)
    v_mfma_f32_32x32x16_bf16 v[96:111], v[64:67], v[80:83], v[96:111]
    ds_read_b128 v[240:243], v42 offset:0
    ds_read_b128 v[244:247], v42 offset:4096
    v_mfma_f32_32x32x16_bf16 v[160:175], v[64:67], v[84:87], v[160:175]
    ds_read_b64_tr_b16 v[224:225], v36 offset:0
    ds_read_b64_tr_b16 v[226:227], v36 offset:2048
    v_mfma_f32_32x32x16_bf16 v[112:127], v[68:71], v[80:83], v[112:127]
    ds_read_b64_tr_b16 v[228:229], v37 offset:0
    ds_read_b64_tr_b16 v[230:231], v37 offset:2048
    v_mfma_f32_32x32x16_bf16 v[176:191], v[68:71], v[84:87], v[176:191]
    ds_read_b64_tr_b16 v[232:233], v38 offset:0
    ds_read_b64_tr_b16 v[234:235], v38 offset:2048
    v_mfma_f32_32x32x16_bf16 v[128:143], v[72:75], v[80:83], v[128:143]
    ds_read_b64_tr_b16 v[236:237], v39 offset:0
    ds_read_b64_tr_b16 v[238:239], v39 offset:2048
    v_mfma_f32_32x32x16_bf16 v[192:207], v[72:75], v[84:87], v[192:207]
    v_mfma_f32_32x32x16_bf16 v[144:159], v[76:79], v[80:83], v[144:159]
    v_mfma_f32_32x32x16_bf16 v[208:223], v[76:79], v[84:87], v[208:223]
    s_waitcnt lgkmcnt(0)
    v_mfma_f32_32x32x16_bf16 v[96:111], v[224:227], v[240:243], v[96:111]
    ds_read_b128 v[80:83], v43 offset:0
    ds_read_b128 v[84:87], v43 offset:4096
    v_mfma_f32_32x32x16_bf16 v[160:175], v[224:227], v[244:247], v[160:175]
    ds_read_b64_tr_b16 v[64:65], v36 offset:8192
    ds_read_b64_tr_b16 v[66:67], v36 offset:10240
    v_mfma_f32_32x32x16_bf16 v[112:127], v[228:231], v[240:243], v[112:127]
    ds_read_b64_tr_b16 v[68:69], v37 offset:8192
    ds_read_b64_tr_b16 v[70:71], v37 offset:10240
    v_mfma_f32_32x32x16_bf16 v[176:191], v[228:231], v[244:247], v[176:191]
    ds_read_b64_tr_b16 v[72:73], v38 offset:8192
    ds_read_b64_tr_b16 v[74:75], v38 offset:10240
    v_mfma_f32_32x32x16_bf16 v[128:143], v[232:235], v[240:243], v[128:143]
    ds_read_b64_tr_b16 v[76:77], v39 offset:8192
    ds_read_b64_tr_b16 v[78:79], v39 offset:10240
    v_mfma_f32_32x32x16_bf16 v[192:207], v[232:235], v[244:247], v[192:207]
    v_mfma_f32_32x32x16_bf16 v[144:159], v[236:239], v[240:243], v[144:159]
    v_mfma_f32_32x32x16_bf16 v[208:223], v[236:239], v[244:247], v[208:223]
    s_waitcnt lgkmcnt(0)
    v_mfma_f32_32x32x16_bf16 v[96:111], v[64:67], v[80:83], v[96:111]
    v_mfma_f32_32x32x16_bf16 v[160:175], v[64:67], v[84:87], v[160:175]
    v_mfma_f32_32x32x16_bf16 v[112:127], v[68:71], v[80:83], v[112:127]
    v_mfma_f32_32x32x16_bf16 v[176:191], v[68:71], v[84:87], v[176:191]
    v_mfma_f32_32x32x16_bf16 v[128:143], v[72:75], v[80:83], v[128:143]
    v_mfma_f32_32x32x16_bf16 v[192:207], v[72:75], v[84:87], v[192:207]
    v_mfma_f32_32x32x16_bf16 v[144:159], v[76:79], v[80:83], v[144:159]
    v_mfma_f32_32x32x16_bf16 v[208:223], v[76:79], v[84:87], v[208:223]
    s_lshr_b32 s3, s5, 1
    s_cmp_eq_u32 s3, 0
    s_cselect_b32 s3, 2, 3
    s_lshl_b32 s3, s3, 14
    s_and_b32 s52, s5, 1
    s_lshl_b32 s52, s52, 13
    s_add_u32 s3, s3, s52
    v_lshlrev_b32 v6, 4, v0
    v_add_u32 v6, s3, v6
    v_mul_f32 v160, s57, v160
    v_mul_f32 v161, s57, v161
    v_mul_f32 v162, s57, v162
    v_mul_f32 v163, s57, v163
    v_mul_f32 v164, s57, v164
    v_mul_f32 v165, s57, v165
    v_mul_f32 v166, s57, v166
    v_mul_f32 v167, s57, v167
    v_mul_f32 v168, s57, v168
    v_mul_f32 v169, s57, v169
    v_mul_f32 v170, s57, v170
    v_mul_f32 v171, s57, v171
    v_mul_f32 v172, s57, v172
    v_mul_f32 v173, s57, v173
    v_mul_f32 v174, s57, v174
    v_mul_f32 v175, s57, v175
    v_mul_f32 v176, s57, v176
    v_mul_f32 v177, s57, v177
    v_mul_f32 v178, s57, v178
    v_mul_f32 v179, s57, v179
    v_mul_f32 v180, s57, v180
    v_mul_f32 v181, s57, v181
    v_mul_f32 v182, s57, v182
    v_mul_f32 v183, s57, v183
    v_mul_f32 v184, s57, v184
    v_mul_f32 v185, s57, v185
    v_mul_f32 v186, s57, v186
    v_mul_f32 v187, s57, v187
    v_mul_f32 v188, s57, v188
    v_mul_f32 v189, s57, v189
    v_mul_f32 v190, s57, v190
    v_mul_f32 v191, s57, v191
    v_mul_f32 v192, s57, v192
    v_mul_f32 v193, s57, v193
    v_mul_f32 v194, s57, v194
    v_mul_f32 v195, s57, v195
    v_mul_f32 v196, s57, v196
    v_mul_f32 v197, s57, v197
    v_mul_f32 v198, s57, v198
    v_mul_f32 v199, s57, v199
    v_mul_f32 v200, s57, v200
    v_mul_f32 v201, s57, v201
    v_mul_f32 v202, s57, v202
    v_mul_f32 v203, s57, v203
    v_mul_f32 v204, s57, v204
    v_mul_f32 v205, s57, v205
    v_mul_f32 v206, s57, v206
    v_mul_f32 v207, s57, v207
    v_mul_f32 v208, s57, v208
    v_mul_f32 v209, s57, v209
    v_mul_f32 v210, s57, v210
    v_mul_f32 v211, s57, v211
    v_mul_f32 v212, s57, v212
    v_mul_f32 v213, s57, v213
    v_mul_f32 v214, s57, v214
    v_mul_f32 v215, s57, v215
    v_mul_f32 v216, s57, v216
    v_mul_f32 v217, s57, v217
    v_mul_f32 v218, s57, v218
    v_mul_f32 v219, s57, v219
    v_mul_f32 v220, s57, v220
    v_mul_f32 v221, s57, v221
    v_mul_f32 v222, s57, v222
    v_mul_f32 v223, s57, v223
    v_cvt_pk_bf16_f32 v224, v160, v161
    v_cvt_pk_bf16_f32 v225, v162, v163
    v_cvt_pk_bf16_f32 v226, v164, v165
    v_cvt_pk_bf16_f32 v227, v166, v167
    ds_write_b128 v6, v[224:227] offset:0
    v_cvt_pk_bf16_f32 v228, v168, v169
    v_cvt_pk_bf16_f32 v229, v170, v171
    v_cvt_pk_bf16_f32 v230, v172, v173
    v_cvt_pk_bf16_f32 v231, v174, v175
    ds_write_b128 v6, v[228:231] offset:1024
    v_cvt_pk_bf16_f32 v232, v176, v177
    v_cvt_pk_bf16_f32 v233, v178, v179
    v_cvt_pk_bf16_f32 v234, v180, v181
    v_cvt_pk_bf16_f32 v235, v182, v183
    ds_write_b128 v6, v[232:235] offset:2048
    v_cvt_pk_bf16_f32 v236, v184, v185
    v_cvt_pk_bf16_f32 v237, v186, v187
    v_cvt_pk_bf16_f32 v238, v188, v189
    v_cvt_pk_bf16_f32 v239, v190, v191
    ds_write_b128 v6, v[236:239] offset:3072
    v_cvt_pk_bf16_f32 v240, v192, v193
    v_cvt_pk_bf16_f32 v241, v194, v195
    v_cvt_pk_bf16_f32 v242, v196, v197
    v_cvt_pk_bf16_f32 v243, v198, v199
    ds_write_b128 v6, v[240:243] offset:4096
    v_cvt_pk_bf16_f32 v244, v200, v201
    v_cvt_pk_bf16_f32 v245, v202, v203
    v_cvt_pk_bf16_f32 v246, v204, v205
    v_cvt_pk_bf16_f32 v247, v206, v207
    ds_write_b128 v6, v[244:247] offset:5120
    v_cvt_pk_bf16_f32 v248, v208, v209
    v_cvt_pk_bf16_f32 v249, v210, v211
    v_cvt_pk_bf16_f32 v250, v212, v213
    v_cvt_pk_bf16_f32 v251, v214, v215
    ds_write_b128 v6, v[248:251] offset:6144
    v_cvt_pk_bf16_f32 v252, v216, v217
    v_cvt_pk_bf16_f32 v253, v218, v219
    v_cvt_pk_bf16_f32 v254, v220, v221
    v_cvt_pk_bf16_f32 v255, v222, v223
    ds_write_b128 v6, v[252:255] offset:7168
    v_mul_f32 v96, s57, v96
    v_mul_f32 v97, s57, v97
    v_mul_f32 v98, s57, v98
    v_mul_f32 v99, s57, v99
    v_mul_f32 v100, s57, v100
    v_mul_f32 v101, s57, v101
    v_mul_f32 v102, s57, v102
    v_mul_f32 v103, s57, v103
    v_mul_f32 v104, s57, v104
    v_mul_f32 v105, s57, v105
    v_mul_f32 v106, s57, v106
    v_mul_f32 v107, s57, v107
    v_mul_f32 v108, s57, v108
    v_mul_f32 v109, s57, v109
    v_mul_f32 v110, s57, v110
    v_mul_f32 v111, s57, v111
    v_mul_f32 v112, s57, v112
    v_mul_f32 v113, s57, v113
    v_mul_f32 v114, s57, v114
    v_mul_f32 v115, s57, v115
    v_mul_f32 v116, s57, v116
    v_mul_f32 v117, s57, v117
    v_mul_f32 v118, s57, v118
    v_mul_f32 v119, s57, v119
    v_mul_f32 v120, s57, v120
    v_mul_f32 v121, s57, v121
    v_mul_f32 v122, s57, v122
    v_mul_f32 v123, s57, v123
    v_mul_f32 v124, s57, v124
    v_mul_f32 v125, s57, v125
    v_mul_f32 v126, s57, v126
    v_mul_f32 v127, s57, v127
    v_mul_f32 v128, s57, v128
    v_mul_f32 v129, s57, v129
    v_mul_f32 v130, s57, v130
    v_mul_f32 v131, s57, v131
    v_mul_f32 v132, s57, v132
    v_mul_f32 v133, s57, v133
    v_mul_f32 v134, s57, v134
    v_mul_f32 v135, s57, v135
    v_mul_f32 v136, s57, v136
    v_mul_f32 v137, s57, v137
    v_mul_f32 v138, s57, v138
    v_mul_f32 v139, s57, v139
    v_mul_f32 v140, s57, v140
    v_mul_f32 v141, s57, v141
    v_mul_f32 v142, s57, v142
    v_mul_f32 v143, s57, v143
    v_mul_f32 v144, s57, v144
    v_mul_f32 v145, s57, v145
    v_mul_f32 v146, s57, v146
    v_mul_f32 v147, s57, v147
    v_mul_f32 v148, s57, v148
    v_mul_f32 v149, s57, v149
    v_mul_f32 v150, s57, v150
    v_mul_f32 v151, s57, v151
    v_mul_f32 v152, s57, v152
    v_mul_f32 v153, s57, v153
    v_mul_f32 v154, s57, v154
    v_mul_f32 v155, s57, v155
    v_mul_f32 v156, s57, v156
    v_mul_f32 v157, s57, v157
    v_mul_f32 v158, s57, v158
    v_mul_f32 v159, s57, v159
    v_cvt_pk_bf16_f32 v64, v96, v97
    v_cvt_pk_bf16_f32 v65, v98, v99
    v_cvt_pk_bf16_f32 v66, v100, v101
    v_cvt_pk_bf16_f32 v67, v102, v103
    v_cvt_pk_bf16_f32 v68, v104, v105
    v_cvt_pk_bf16_f32 v69, v106, v107
    v_cvt_pk_bf16_f32 v70, v108, v109
    v_cvt_pk_bf16_f32 v71, v110, v111
    v_cvt_pk_bf16_f32 v72, v112, v113
    v_cvt_pk_bf16_f32 v73, v114, v115
    v_cvt_pk_bf16_f32 v74, v116, v117
    v_cvt_pk_bf16_f32 v75, v118, v119
    v_cvt_pk_bf16_f32 v76, v120, v121
    v_cvt_pk_bf16_f32 v77, v122, v123
    v_cvt_pk_bf16_f32 v78, v124, v125
    v_cvt_pk_bf16_f32 v79, v126, v127
    v_cvt_pk_bf16_f32 v80, v128, v129
    v_cvt_pk_bf16_f32 v81, v130, v131
    v_cvt_pk_bf16_f32 v82, v132, v133
    v_cvt_pk_bf16_f32 v83, v134, v135
    v_cvt_pk_bf16_f32 v84, v136, v137
    v_cvt_pk_bf16_f32 v85, v138, v139
    v_cvt_pk_bf16_f32 v86, v140, v141
    v_cvt_pk_bf16_f32 v87, v142, v143
    v_cvt_pk_bf16_f32 v88, v144, v145
    v_cvt_pk_bf16_f32 v89, v146, v147
    v_cvt_pk_bf16_f32 v90, v148, v149
    v_cvt_pk_bf16_f32 v91, v150, v151
    v_cvt_pk_bf16_f32 v92, v152, v153
    v_cvt_pk_bf16_f32 v93, v154, v155
    v_cvt_pk_bf16_f32 v94, v156, v157
    v_cvt_pk_bf16_f32 v95, v158, v159
    s_waitcnt lgkmcnt(0)
    s_waitcnt vmcnt(0)
K1_ATT:
    s_nop 4
    s_lshr_b32 s55, s5, 1
    s_waitcnt vmcnt(8)
    s_barrier
    s_cmp_lt_u32 s5, 4
    s_cbranch_scc1 K1_QGOT
    s_bfe_u32 s3, s5, 0x10001
    s_cmp_eq_u32 s3, 0
    s_cselect_b32 s3, 2, 3
    s_lshl_b32 s3, s3, 14
    s_and_b32 s52, s5, 1
    s_lshl_b32 s52, s52, 13
    s_add_u32 s3, s3, s52
    v_lshlrev_b32 v6, 4, v0
    v_add_u32 v6, s3, v6
    ds_read_b128 v[64:67], v6 offset:0
    ds_read_b128 v[68:71], v6 offset:1024
    ds_read_b128 v[72:75], v6 offset:2048
    ds_read_b128 v[76:79], v6 offset:3072
    ds_read_b128 v[80:83], v6 offset:4096
    ds_read_b128 v[84:87], v6 offset:5120
    ds_read_b128 v[88:91], v6 offset:6144
    ds_read_b128 v[92:95], v6 offset:7168
    s_waitcnt lgkmcnt(0)
K1_QGOT:
    s_nop 1
    v_add_u32 v8, 131072, v16
    v_xor_b32 v9, 32, v8
    v_xor_b32 v10, 64, v8
    v_xor_b32 v11, 96, v8
    v_xor_b32 v14, 128, v8
    v_xor_b32 v15, 160, v8
    v_xor_b32 v4, 192, v8
    v_xor_b32 v5, 224, v8
    v_add_u32 v24, 147456, v16
    v_xor_b32 v25, 32, v24
    v_xor_b32 v26, 64, v24
    v_xor_b32 v27, 96, v24
    v_xor_b32 v28, 128, v24
    v_xor_b32 v29, 160, v24
    v_xor_b32 v30, 192, v24
    v_xor_b32 v31, 224, v24
    ds_read_b128 v[32:35], v8 offset:0
    ds_read_b128 v[36:39], v9 offset:0
    ds_read_b128 v[40:43], v10 offset:0
    ds_read_b128 v[44:47], v11 offset:0
    s_waitcnt lgkmcnt(3)
    v_mfma_f32_32x32x16_bf16 v[96:111], v[32:35], v[64:67], 0
    ds_read_b128 v[32:35], v14 offset:0
    s_cmp_eq_u32 s55, 0
    s_cbranch_scc0 K1_D0
    s_add_u32 s52, s51, 49152
    s_add_u32 m0, s48, 81920
    s_nop 0
    buffer_load_dwordx4 v12, s[36:39], s52 offen nt lds
K1_D0:
    s_waitcnt lgkmcnt(3)
    v_mfma_f32_32x32x16_bf16 v[96:111], v[36:39], v[68:71], v[96:111]
    ds_read_b128 v[36:39], v15 offset:0
    s_cmp_eq_u32 s55, 1
    s_cbranch_scc0 K1_D1
    s_add_u32 s52, s51, 49152
    s_add_u32 m0, s48, 81920
    s_nop 0
    buffer_load_dwordx4 v12, s[36:39], s52 offen nt lds
K1_D1:
    s_waitcnt lgkmcnt(3)
    v_mfma_f32_32x32x16_bf16 v[96:111], v[40:43], v[72:75], v[96:111]
    ds_read_b128 v[40:43], v4 offset:0
    s_cmp_eq_u32 s55, 2
    s_cbranch_scc0 K1_D2
    s_add_u32 s52, s51, 49152
    s_add_u32 m0, s48, 81920
    s_nop 0
    buffer_load_dwordx4 v12, s[36:39], s52 offen nt lds
K1_D2:
    s_waitcnt lgkmcnt(3)
    v_mfma_f32_32x32x16_bf16 v[96:111], v[44:47], v[76:79], v[96:111]
    ds_read_b128 v[44:47], v5 offset:0
    s_cmp_eq_u32 s55, 3
    s_cbranch_scc0 K1_D3
    s_add_u32 s52, s51, 49152
    s_add_u32 m0, s48, 81920
    s_nop 0
    buffer_load_dwordx4 v12, s[36:39], s52 offen nt lds
K1_D3:
    s_waitcnt lgkmcnt(3)
    v_mfma_f32_32x32x16_bf16 v[96:111], v[32:35], v[80:83], v[96:111]
    ds_read_b128 v[32:35], v8 offset:8192
    s_cmp_eq_u32 s55, 0
    s_cbranch_scc0 K1_D4
    s_add_u32 s52, s51, 49152
    s_add_u32 m0, s48, 82944
    s_nop 0
    buffer_load_dwordx4 v13, s[36:39], s52 offen nt lds
K1_D4:
    s_waitcnt lgkmcnt(3)
    v_mfma_f32_32x32x16_bf16 v[96:111], v[36:39], v[84:87], v[96:111]
    ds_read_b128 v[36:39], v9 offset:8192
    s_cmp_eq_u32 s55, 1
    s_cbranch_scc0 K1_D5
    s_add_u32 s52, s51, 49152
    s_add_u32 m0, s48, 82944
    s_nop 0
    buffer_load_dwordx4 v13, s[36:39], s52 offen nt lds
K1_D5:
    s_waitcnt lgkmcnt(3)
    v_mfma_f32_32x32x16_bf16 v[96:111], v[40:43], v[88:91], v[96:111]
    ds_read_b128 v[40:43], v10 offset:8192
    s_cmp_eq_u32 s55, 2
    s_cbranch_scc0 K1_D6
    s_add_u32 s52, s51, 49152
    s_add_u32 m0, s48, 82944
    s_nop 0
    buffer_load_dwordx4 v13, s[36:39], s52 offen nt lds
K1_D6:
    s_waitcnt lgkmcnt(3)
    v_mfma_f32_32x32x16_bf16 v[96:111], v[44:47], v[92:95], v[96:111]
    ds_read_b128 v[44:47], v11 offset:8192
    s_cmp_eq_u32 s55, 3
    s_cbranch_scc0 K1_D7
    s_add_u32 s52, s51, 49152
    s_add_u32 m0, s48, 82944
    s_nop 0
    buffer_load_dwordx4 v13, s[36:39], s52 offen nt lds
K1_D7:
    s_waitcnt lgkmcnt(3)
    v_mfma_f32_32x32x16_bf16 v[112:127], v[32:35], v[64:67], 0
    ds_read_b128 v[32:35], v14 offset:8192
    s_cmp_eq_u32 s55, 0
    s_cbranch_scc0 K1_D8
    s_add_u32 s52, s51, 32768
    s_add_u32 m0, s48, 98304
    s_nop 0
    buffer_load_dwordx4 v12, s[40:43], s52 offen nt lds
K1_D8:
    s_waitcnt lgkmcnt(3)
    v_mfma_f32_32x32x16_bf16 v[112:127], v[36:39], v[68:71], v[112:127]
    ds_read_b128 v[36:39], v15 offset:8192
    s_cmp_eq_u32 s55, 1
    s_cbranch_scc0 K1_D9
    s_add_u32 s52, s51, 32768
    s_add_u32 m0, s48, 98304
    s_nop 0
    buffer_load_dwordx4 v12, s[40:43], s52 offen nt lds
K1_D9:
    s_waitcnt lgkmcnt(3)
    v_mfma_f32_32x32x16_bf16 v[112:127], v[40:43], v[72:75], v[112:127]
    ds_read_b128 v[40:43], v4 offset:8192
    s_cmp_eq_u32 s55, 2
    s_cbranch_scc0 K1_D10
    s_add_u32 s52, s51, 32768
    s_add_u32 m0, s48, 98304
    s_nop 0
    buffer_load_dwordx4 v12, s[40:43], s52 offen nt lds
K1_D10:
    s_waitcnt lgkmcnt(3)
    v_mfma_f32_32x32x16_bf16 v[112:127], v[44:47], v[76:79], v[112:127]
    ds_read_b128 v[44:47], v5 offset:8192
    s_cmp_eq_u32 s55, 3
    s_cbranch_scc0 K1_D11
    s_add_u32 s52, s51, 32768
    s_add_u32 m0, s48, 98304
    s_nop 0
    buffer_load_dwordx4 v12, s[40:43], s52 offen nt lds
K1_D11:
    s_waitcnt lgkmcnt(3)
    v_mfma_f32_32x32x16_bf16 v[112:127], v[32:35], v[80:83], v[112:127]
    ds_read_b128 v[32:35], v24 offset:0
    s_cmp_eq_u32 s55, 0
    s_cbranch_scc0 K1_D12
    s_add_u32 s52, s51, 32768
    s_add_u32 m0, s48, 99328
    s_nop 0
    buffer_load_dwordx4 v13, s[40:43], s52 offen nt lds
K1_D12:
    s_waitcnt lgkmcnt(3)
    v_mfma_f32_32x32x16_bf16 v[112:127], v[36:39], v[84:87], v[112:127]
    ds_read_b128 v[36:39], v25 offset:0
    s_cmp_eq_u32 s55, 1
    s_cbranch_scc0 K1_D13
    s_add_u32 s52, s51, 32768
    s_add_u32 m0, s48, 99328
    s_nop 0
    buffer_load_dwordx4 v13, s[40:43], s52 offen nt lds
K1_D13:
    s_waitcnt lgkmcnt(3)
    v_mfma_f32_32x32x16_bf16 v[112:127], v[40:43], v[88:91], v[112:127]
    ds_read_b128 v[40:43], v26 offset:0
    s_cmp_eq_u32 s55, 2
    s_cbranch_scc0 K1_D14
    s_add_u32 s52, s51, 32768
    s_add_u32 m0, s48, 99328
    s_nop 0
    buffer_load_dwordx4 v13, s[40:43], s52 offen nt lds
K1_D14:
    s_waitcnt lgkmcnt(3)
    v_mfma_f32_32x32x16_bf16 v[112:127], v[44:47], v[92:95], v[112:127]
    ds_read_b128 v[44:47], v27 offset:0
    s_cmp_eq_u32 s55, 3
    s_cbranch_scc0 K1_D15
    s_add_u32 s52, s51, 32768
    s_add_u32 m0, s48, 99328
    s_nop 0
    buffer_load_dwordx4 v13, s[40:43], s52 offen nt lds
K1_D15:
    s_waitcnt lgkmcnt(3)
    v_mfma_f32_32x32x16_bf16 v[128:143], v[32:35], v[64:67], 0
    ds_read_b128 v[32:35], v28 offset:0
    v_add_u32 v8, 0, v17
    s_cmp_eq_u32 s55, 0
    s_cbranch_scc0 K1_D16
    s_add_u32 s52, s51, 65536
    s_add_u32 m0, s48, 114688
    s_nop 0
    buffer_load_dwordx4 v12, s[36:39], s52 offen nt lds
K1_D16:
    s_waitcnt lgkmcnt(3)
    v_mfma_f32_32x32x16_bf16 v[128:143], v[36:39], v[68:71], v[128:143]
    ds_read_b128 v[36:39], v29 offset:0
    v_xor_b32 v9, 32, v8
    v_max3_f32 v22, v96, v97, v98
    v_max3_f32 v23, v99, v100, v101
    v_max3_f32 v22, v22, v102, v103
    v_max3_f32 v23, v23, v104, v105
    v_max3_f32 v22, v22, v106, v107
    v_max3_f32 v23, v23, v108, v109
    v_max3_f32 v22, v22, v110, v111
    v_max3_f32 v23, v23, v112, v113
    v_max3_f32 v22, v22, v114, v115
    s_cmp_eq_u32 s55, 1
    s_cbranch_scc0 K1_D17
    s_add_u32 s52, s51, 65536
    s_add_u32 m0, s48, 114688
    s_nop 0
    buffer_load_dwordx4 v12, s[36:39], s52 offen nt lds
K1_D17:
    s_waitcnt lgkmcnt(3)
    v_mfma_f32_32x32x16_bf16 v[128:143], v[40:43], v[72:75], v[128:143]
    ds_read_b128 v[40:43], v30 offset:0
    v_max3_f32 v23, v23, v116, v117
    v_max3_f32 v22, v22, v118, v119
    v_max3_f32 v23, v23, v120, v121
    v_max3_f32 v22, v22, v122, v123
    v_max3_f32 v23, v23, v124, v125
    v_max3_f32 v22, v22, v126, v127
    v_max_f32 v22, v22, v23
    v_mov_b32 v23, v22
    s_nop 1
    v_permlane32_swap_b32 v22, v23
    s_cmp_eq_u32 s55, 2
    s_cbranch_scc0 K1_D18
    s_add_u32 s52, s51, 65536
    s_add_u32 m0, s48, 114688
    s_nop 0
    buffer_load_dwordx4 v12, s[36:39], s52 offen nt lds
K1_D18:
    s_waitcnt lgkmcnt(3)
    v_mfma_f32_32x32x16_bf16 v[128:143], v[44:47], v[76:79], v[128:143]
    ds_read_b128 v[44:47], v31 offset:0
    v_xor_b32 v10, 64, v8
    v_max_f32 v22, v22, v23
    v_sub_f32 v96, v96, v22
    v_sub_f32 v97, v97, v22
    v_exp_f32 v0, v96
    v_sub_f32 v98, v98, v22
    v_exp_f32 v1, v97
    v_mov_b32 v20, v0
    v_sub_f32 v99, v99, v22
    v_exp_f32 v2, v98
    s_cmp_eq_u32 s55, 3
    s_cbranch_scc0 K1_D19
    s_add_u32 s52, s51, 65536
    s_add_u32 m0, s48, 114688
    s_nop 0
    buffer_load_dwordx4 v12, s[36:39], s52 offen nt lds
K1_D19:
    s_waitcnt lgkmcnt(3)
    v_mfma_f32_32x32x16_bf16 v[128:143], v[32:35], v[80:83], v[128:143]
    ds_read_b128 v[32:35], v24 offset:8192
    v_xor_b32 v11, 96, v8
    v_mov_b32 v21, v1
    v_cvt_pk_bf16_f32 v224, v0, v1
    v_sub_f32 v100, v100, v22
    v_exp_f32 v3, v99
    v_add_f32 v20, v20, v2
    v_sub_f32 v101, v101, v22
    v_exp_f32 v0, v100
    v_add_f32 v21, v21, v3
    s_cmp_eq_u32 s55, 0
    s_cbranch_scc0 K1_D20
    s_add_u32 s52, s51, 65536
    s_add_u32 m0, s48, 115712
    s_nop 0
    buffer_load_dwordx4 v13, s[36:39], s52 offen nt lds
K1_D20:
    s_waitcnt lgkmcnt(3)
    v_mfma_f32_32x32x16_bf16 v[128:143], v[36:39], v[84:87], v[128:143]
    ds_read_b128 v[36:39], v25 offset:8192
    v_cvt_pk_bf16_f32 v225, v2, v3
    v_sub_f32 v102, v102, v22
    v_exp_f32 v1, v101
    v_add_f32 v20, v20, v0
    v_sub_f32 v103, v103, v22
    v_exp_f32 v2, v102
    v_add_f32 v21, v21, v1
    v_cvt_pk_bf16_f32 v226, v0, v1
    v_sub_f32 v104, v104, v22
    s_cmp_eq_u32 s55, 1
    s_cbranch_scc0 K1_D21
    s_add_u32 s52, s51, 65536
    s_add_u32 m0, s48, 115712
    s_nop 0
    buffer_load_dwordx4 v13, s[36:39], s52 offen nt lds
K1_D21:
    s_waitcnt lgkmcnt(3)
    v_mfma_f32_32x32x16_bf16 v[128:143], v[40:43], v[88:91], v[128:143]
    ds_read_b128 v[40:43], v26 offset:8192
    v_xor_b32 v14, 128, v8
    v_exp_f32 v3, v103
    v_add_f32 v20, v20, v2
    v_sub_f32 v105, v105, v22
    v_exp_f32 v0, v104
    v_add_f32 v21, v21, v3
    v_cvt_pk_bf16_f32 v227, v2, v3
    v_sub_f32 v106, v106, v22
    v_exp_f32 v1, v105
    v_add_f32 v20, v20, v0
    s_cmp_eq_u32 s55, 2
    s_cbranch_scc0 K1_D22
    s_add_u32 s52, s51, 65536
    s_add_u32 m0, s48, 115712
    s_nop 0
    buffer_load_dwordx4 v13, s[36:39], s52 offen nt lds
K1_D22:
    s_waitcnt lgkmcnt(3)
    v_mfma_f32_32x32x16_bf16 v[128:143], v[44:47], v[92:95], v[128:143]
    ds_read_b128 v[44:47], v27 offset:8192
    v_xor_b32 v15, 160, v8
    v_sub_f32 v107, v107, v22
    v_exp_f32 v2, v106
    v_add_f32 v21, v21, v1
    v_cvt_pk_bf16_f32 v228, v0, v1
    v_sub_f32 v108, v108, v22
    v_exp_f32 v3, v107
    v_add_f32 v20, v20, v2
    v_sub_f32 v109, v109, v22
    v_exp_f32 v0, v108
    s_cmp_eq_u32 s55, 3
    s_cbranch_scc0 K1_D23
    s_add_u32 s52, s51, 65536
    s_add_u32 m0, s48, 115712
    s_nop 0
    buffer_load_dwordx4 v13, s[36:39], s52 offen nt lds
K1_D23:
    s_waitcnt lgkmcnt(3)
    v_mfma_f32_32x32x16_bf16 v[144:159], v[32:35], v[64:67], 0
    ds_read_b128 v[32:35], v28 offset:8192
    v_add_f32 v21, v21, v3
    v_cvt_pk_bf16_f32 v229, v2, v3
    v_sub_f32 v110, v110, v22
    v_exp_f32 v1, v109
    v_add_f32 v20, v20, v0
    v_sub_f32 v111, v111, v22
    v_exp_f32 v2, v110
    v_add_f32 v21, v21, v1
    s_waitcnt lgkmcnt(3)
    v_mfma_f32_32x32x16_bf16 v[144:159], v[36:39], v[68:71], v[144:159]
    ds_read_b128 v[36:39], v29 offset:8192
    v_xor_b32 v4, 192, v8
    v_cvt_pk_bf16_f32 v230, v0, v1
    v_sub_f32 v112, v112, v22
    v_exp_f32 v3, v111
    v_add_f32 v20, v20, v2
    v_sub_f32 v113, v113, v22
    v_exp_f32 v0, v112
    v_add_f32 v21, v21, v3
    v_cvt_pk_bf16_f32 v231, v2, v3
    v_sub_f32 v114, v114, v22
    s_waitcnt lgkmcnt(3)
    v_mfma_f32_32x32x16_bf16 v[144:159], v[40:43], v[72:75], v[144:159]
    ds_read_b128 v[40:43], v30 offset:8192
    v_xor_b32 v5, 224, v8
    v_exp_f32 v1, v113
    v_add_f32 v20, v20, v0
    v_sub_f32 v115, v115, v22
    v_exp_f32 v2, v114
    v_add_f32 v21, v21, v1
    v_cvt_pk_bf16_f32 v232, v0, v1
    v_sub_f32 v116, v116, v22
    v_exp_f32 v3, v115
    v_add_f32 v20, v20, v2
    s_waitcnt lgkmcnt(3)
    v_mfma_f32_32x32x16_bf16 v[144:159], v[44:47], v[76:79], v[144:159]
    ds_read_b128 v[44:47], v31 offset:8192
    v_sub_f32 v117, v117, v22
    v_exp_f32 v0, v116
    v_add_f32 v21, v21, v3
    v_cvt_pk_bf16_f32 v233, v2, v3
    v_sub_f32 v118, v118, v22
    v_exp_f32 v1, v117
    v_add_f32 v20, v20, v0
    v_sub_f32 v119, v119, v22
    v_exp_f32 v2, v118
    s_waitcnt lgkmcnt(3)
    v_mfma_f32_32x32x16_bf16 v[144:159], v[32:35], v[80:83], v[144:159]
    ds_read_b64_tr_b16 v[32:33], v8 offset:0
    ds_read_b64_tr_b16 v[34:35], v9 offset:2048
    v_add_f32 v21, v21, v1
    v_cvt_pk_bf16_f32 v234, v0, v1
    v_sub_f32 v120, v120, v22
    v_exp_f32 v3, v119
    v_add_f32 v20, v20, v2
    v_sub_f32 v121, v121, v22
    v_exp_f32 v0, v120
    v_add_f32 v21, v21, v3
    s_waitcnt lgkmcnt(4)
    v_mfma_f32_32x32x16_bf16 v[144:159], v[36:39], v[84:87], v[144:159]
    ds_read_b64_tr_b16 v[36:37], v10 offset:0
    ds_read_b64_tr_b16 v[38:39], v11 offset:2048
    v_cvt_pk_bf16_f32 v235, v2, v3
    v_sub_f32 v122, v122, v22
    v_exp_f32 v1, v121
    v_add_f32 v20, v20, v0
    v_sub_f32 v123, v123, v22
    v_exp_f32 v2, v122
    v_add_f32 v21, v21, v1
    v_cvt_pk_bf16_f32 v236, v0, v1
    v_sub_f32 v124, v124, v22
    s_waitcnt lgkmcnt(5)
    v_mfma_f32_32x32x16_bf16 v[144:159], v[40:43], v[88:91], v[144:159]
    ds_read_b64_tr_b16 v[40:41], v14 offset:0
    ds_read_b64_tr_b16 v[42:43], v15 offset:2048
    v_exp_f32 v3, v123
    v_add_f32 v20, v20, v2
    v_sub_f32 v125, v125, v22
    v_exp_f32 v0, v124
    v_add_f32 v21, v21, v3
    v_cvt_pk_bf16_f32 v237, v2, v3
    v_sub_f32 v126, v126, v22
    v_exp_f32 v1, v125
    v_add_f32 v20, v20, v0
    s_waitcnt lgkmcnt(6)
    v_mfma_f32_32x32x16_bf16 v[144:159], v[44:47], v[92:95], v[144:159]
    ds_read_b64_tr_b16 v[44:45], v4 offset:0
    ds_read_b64_tr_b16 v[46:47], v5 offset:2048
    v_sub_f32 v127, v127, v22
    v_exp_f32 v2, v126
    v_add_f32 v21, v21, v1
    v_cvt_pk_bf16_f32 v238, v0, v1
    v_exp_f32 v3, v127
    v_add_f32 v20, v20, v2
    v_add_f32 v21, v21, v3
    v_cvt_pk_bf16_f32 v239, v2, v3
    v_add_f32 v20, v20, v21
    v_add_f32 v18, v18, v20
    s_waitcnt lgkmcnt(6)
    v_mfma_f32_32x32x16_bf16 v[160:175], v[32:35], v[224:227], 0
    ds_read_b64_tr_b16 v[32:33], v8 offset:4096
    ds_read_b64_tr_b16 v[34:35], v9 offset:6144
    v_add_u32 v24, 16384, v16
    v_sub_f32 v48, 0, v22
    v_sub_f32 v49, 0, v22
    v_sub_f32 v50, 0, v22
    v_sub_f32 v51, 0, v22
    v_sub_f32 v52, 0, v22
    s_waitcnt lgkmcnt(6)
    v_mfma_f32_32x32x16_bf16 v[176:191], v[36:39], v[224:227], 0
    ds_read_b64_tr_b16 v[36:37], v10 offset:4096
    ds_read_b64_tr_b16 v[38:39], v11 offset:6144
    v_xor_b32 v25, 32, v24
    v_sub_f32 v53, 0, v22
    v_sub_f32 v54, 0, v22
    v_sub_f32 v55, 0, v22
    v_sub_f32 v56, 0, v22
    s_waitcnt lgkmcnt(6)
    v_mfma_f32_32x32x16_bf16 v[192:207], v[40:43], v[224:227], 0
    ds_read_b64_tr_b16 v[40:41], v14 offset:4096
    ds_read_b64_tr_b16 v[42:43], v15 offset:6144
    v_sub_f32 v57, 0, v22
    v_sub_f32 v58, 0, v22
    v_sub_f32 v59, 0, v22
    v_sub_f32 v60, 0, v22
    v_sub_f32 v61, 0, v22
    s_waitcnt lgkmcnt(6)
    v_mfma_f32_32x32x16_bf16 v[208:223], v[44:47], v[224:227], 0
    ds_read_b64_tr_b16 v[44:45], v4 offset:4096
    ds_read_b64_tr_b16 v[46:47], v5 offset:6144
    v_xor_b32 v26, 64, v24
    v_sub_f32 v62, 0, v22
    v_sub_f32 v63, 0, v22
    v_sub_f32 v128, v128, v22
    v_sub_f32 v129, v129, v22
    s_waitcnt lgkmcnt(6)
    v_mfma_f32_32x32x16_bf16 v[160:175], v[32:35], v[228:231], v[160:175]
    ds_read_b64_tr_b16 v[32:33], v8 offset:8192
    ds_read_b64_tr_b16 v[34:35], v9 offset:10240
    v_xor_b32 v27, 96, v24
    v_exp_f32 v0, v128
    v_sub_f32 v130, v130, v22
    v_exp_f32 v1, v129
    v_mov_b32 v20, v0
    v_sub_f32 v131, v131, v22
    s_waitcnt lgkmcnt(6)
    v_mfma_f32_32x32x16_bf16 v[176:191], v[36:39], v[228:231], v[176:191]
    ds_read_b64_tr_b16 v[36:37], v10 offset:8192
    ds_read_b64_tr_b16 v[38:39], v11 offset:10240
    v_exp_f32 v2, v130
    v_mov_b32 v21, v1
    v_cvt_pk_bf16_f32 v240, v0, v1
    v_sub_f32 v132, v132, v22
    s_waitcnt lgkmcnt(6)
    v_mfma_f32_32x32x16_bf16 v[192:207], v[40:43], v[228:231], v[192:207]
    ds_read_b64_tr_b16 v[40:41], v14 offset:8192
    ds_read_b64_tr_b16 v[42:43], v15 offset:10240
    v_xor_b32 v28, 128, v24
    v_exp_f32 v3, v131
    v_add_f32 v20, v20, v2
    v_sub_f32 v133, v133, v22
    v_exp_f32 v0, v132
    v_add_f32 v21, v21, v3
    s_waitcnt lgkmcnt(6)
    v_mfma_f32_32x32x16_bf16 v[208:223], v[44:47], v[228:231], v[208:223]
    ds_read_b64_tr_b16 v[44:45], v4 offset:8192
    ds_read_b64_tr_b16 v[46:47], v5 offset:10240
    v_xor_b32 v29, 160, v24
    v_cvt_pk_bf16_f32 v241, v2, v3
    v_sub_f32 v134, v134, v22
    v_exp_f32 v1, v133
    v_add_f32 v20, v20, v0
    s_waitcnt lgkmcnt(6)
    v_mfma_f32_32x32x16_bf16 v[160:175], v[32:35], v[232:235], v[160:175]
    ds_read_b64_tr_b16 v[32:33], v8 offset:12288
    ds_read_b64_tr_b16 v[34:35], v9 offset:14336
    v_sub_f32 v135, v135, v22
    v_exp_f32 v2, v134
    v_add_f32 v21, v21, v1
    v_cvt_pk_bf16_f32 v242, v0, v1
    v_sub_f32 v136, v136, v22
    s_waitcnt lgkmcnt(6)
    v_mfma_f32_32x32x16_bf16 v[176:191], v[36:39], v[232:235], v[176:191]
    ds_read_b64_tr_b16 v[36:37], v10 offset:12288
    ds_read_b64_tr_b16 v[38:39], v11 offset:14336
    v_xor_b32 v30, 192, v24
    v_exp_f32 v3, v135
    v_add_f32 v20, v20, v2
    v_sub_f32 v137, v137, v22
    v_exp_f32 v0, v136
    s_waitcnt lgkmcnt(6)
    v_mfma_f32_32x32x16_bf16 v[192:207], v[40:43], v[232:235], v[192:207]
    ds_read_b64_tr_b16 v[40:41], v14 offset:12288
    ds_read_b64_tr_b16 v[42:43], v15 offset:14336
    v_xor_b32 v31, 224, v24
    v_add_f32 v21, v21, v3
    v_cvt_pk_bf16_f32 v243, v2, v3
    v_sub_f32 v138, v138, v22
    v_exp_f32 v1, v137
    v_add_f32 v20, v20, v0
    s_waitcnt lgkmcnt(6)
    v_mfma_f32_32x32x16_bf16 v[208:223], v[44:47], v[232:235], v[208:223]
    ds_read_b64_tr_b16 v[44:45], v4 offset:12288
    ds_read_b64_tr_b16 v[46:47], v5 offset:14336
    v_sub_f32 v139, v139, v22
    v_exp_f32 v2, v138
    v_add_f32 v21, v21, v1
    v_cvt_pk_bf16_f32 v244, v0, v1
    s_waitcnt lgkmcnt(6)
    v_mfma_f32_32x32x16_bf16 v[160:175], v[32:35], v[236:239], v[160:175]
    s_waitcnt lgkmcnt(0)
    s_waitcnt vmcnt(6)
    s_barrier
    ds_read_b128 v[32:35], v24 offset:0
    v_sub_f32 v140, v140, v22
    v_exp_f32 v3, v139
    v_add_f32 v20, v20, v2
    v_sub_f32 v141, v141, v22
    v_exp_f32 v0, v140
    s_cmp_eq_u32 s55, 0
    s_cbranch_scc0 K1_D24
    s_add_u32 s52, s51, 49152
    s_add_u32 m0, s48, 32768
    s_nop 0
    buffer_load_dwordx4 v12, s[40:43], s52 offen nt lds
K1_D24:
    v_mfma_f32_32x32x16_bf16 v[176:191], v[36:39], v[236:239], v[176:191]
    ds_read_b128 v[36:39], v25 offset:0
    v_add_f32 v21, v21, v3
    v_cvt_pk_bf16_f32 v245, v2, v3
    v_sub_f32 v142, v142, v22
    v_exp_f32 v1, v141
    s_cmp_eq_u32 s55, 1
    s_cbranch_scc0 K1_D25
    s_add_u32 s52, s51, 49152
    s_add_u32 m0, s48, 32768
    s_nop 0
    buffer_load_dwordx4 v12, s[40:43], s52 offen nt lds
K1_D25:
    v_mfma_f32_32x32x16_bf16 v[192:207], v[40:43], v[236:239], v[192:207]
    ds_read_b128 v[40:43], v26 offset:0
    v_add_f32 v20, v20, v0
    v_sub_f32 v143, v143, v22
    v_exp_f32 v2, v142
    v_add_f32 v21, v21, v1
    v_cvt_pk_bf16_f32 v246, v0, v1
    s_cmp_eq_u32 s55, 2
    s_cbranch_scc0 K1_D26
    s_add_u32 s52, s51, 49152
    s_add_u32 m0, s48, 32768
    s_nop 0
    buffer_load_dwordx4 v12, s[40:43], s52 offen nt lds
K1_D26:
    v_mfma_f32_32x32x16_bf16 v[208:223], v[44:47], v[236:239], v[208:223]
    ds_read_b128 v[44:47], v27 offset:0
    v_exp_f32 v3, v143
    v_add_f32 v20, v20, v2
    v_add_f32 v21, v21, v3
    v_cvt_pk_bf16_f32 v247, v2, v3
    s_cmp_eq_u32 s55, 3
    s_cbranch_scc0 K1_D27
    s_add_u32 s52, s51, 49152
    s_add_u32 m0, s48, 32768
    s_nop 0
    buffer_load_dwordx4 v12, s[40:43], s52 offen nt lds
K1_D27:
    s_waitcnt lgkmcnt(3)
    v_mfma_f32_32x32x16_bf16 v[96:111], v[32:35], v[64:67], v[48:63]
    ds_read_b128 v[32:35], v28 offset:0
    v_add_u32 v8, 65536, v17
    v_sub_f32 v144, v144, v22
    v_sub_f32 v145, v145, v22
    v_exp_f32 v0, v144
    v_sub_f32 v146, v146, v22
    s_cmp_eq_u32 s55, 0
    s_cbranch_scc0 K1_D28
    s_add_u32 s52, s51, 49152
    s_add_u32 m0, s48, 33792
    s_nop 0
    buffer_load_dwordx4 v13, s[40:43], s52 offen nt lds
K1_D28:
    s_waitcnt lgkmcnt(3)
    v_mfma_f32_32x32x16_bf16 v[96:111], v[36:39], v[68:71], v[96:111]
    ds_read_b128 v[36:39], v29 offset:0
    v_xor_b32 v9, 32, v8
    v_exp_f32 v1, v145
    v_add_f32 v20, v20, v0
    v_sub_f32 v147, v147, v22
    s_cmp_eq_u32 s55, 1
    s_cbranch_scc0 K1_D29
    s_add_u32 s52, s51, 49152
    s_add_u32 m0, s48, 33792
    s_nop 0
    buffer_load_dwordx4 v13, s[40:43], s52 offen nt lds
K1_D29:
    s_waitcnt lgkmcnt(3)
    v_mfma_f32_32x32x16_bf16 v[96:111], v[40:43], v[72:75], v[96:111]
    ds_read_b128 v[40:43], v30 offset:0
    v_exp_f32 v2, v146
    v_add_f32 v21, v21, v1
    v_cvt_pk_bf16_f32 v248, v0, v1
    v_sub_f32 v148, v148, v22
    s_cmp_eq_u32 s55, 2
    s_cbranch_scc0 K1_D30
    s_add_u32 s52, s51, 49152
    s_add_u32 m0, s48, 33792
    s_nop 0
    buffer_load_dwordx4 v13, s[40:43], s52 offen nt lds
K1_D30:
    s_waitcnt lgkmcnt(3)
    v_mfma_f32_32x32x16_bf16 v[96:111], v[44:47], v[76:79], v[96:111]
    ds_read_b128 v[44:47], v31 offset:0
    v_xor_b32 v10, 64, v8
    v_exp_f32 v3, v147
    v_add_f32 v20, v20, v2
    v_sub_f32 v149, v149, v22
    s_cmp_eq_u32 s55, 3
    s_cbranch_scc0 K1_D31
    s_add_u32 s52, s51, 49152
    s_add_u32 m0, s48, 33792
    s_nop 0
    buffer_load_dwordx4 v13, s[40:43], s52 offen nt lds
K1_D31:
    s_waitcnt lgkmcnt(3)
    v_mfma_f32_32x32x16_bf16 v[96:111], v[32:35], v[80:83], v[96:111]
    ds_read_b128 v[32:35], v24 offset:8192
    v_xor_b32 v11, 96, v8
    v_exp_f32 v0, v148
    v_add_f32 v21, v21, v3
    v_cvt_pk_bf16_f32 v249, v2, v3
    v_sub_f32 v150, v150, v22
    s_cmp_eq_u32 s55, 0
    s_cbranch_scc0 K1_D32
    s_add_u32 s52, s51, 81920
    s_add_u32 m0, s48, 49152
    s_nop 0
    buffer_load_dwordx4 v12, s[36:39], s52 offen nt lds
K1_D32:
    s_waitcnt lgkmcnt(3)
    v_mfma_f32_32x32x16_bf16 v[96:111], v[36:39], v[84:87], v[96:111]
    ds_read_b128 v[36:39], v25 offset:8192
    v_exp_f32 v1, v149
    v_add_f32 v20, v20, v0
    v_sub_f32 v151, v151, v22
    s_cmp_eq_u32 s55, 1
    s_cbranch_scc0 K1_D33
    s_add_u32 s52, s51, 81920
    s_add_u32 m0, s48, 49152
    s_nop 0
    buffer_load_dwordx4 v12, s[36:39], s52 offen nt lds
K1_D33:
    s_waitcnt lgkmcnt(3)
    v_mfma_f32_32x32x16_bf16 v[96:111], v[40:43], v[88:91], v[96:111]
    ds_read_b128 v[40:43], v26 offset:8192
    v_xor_b32 v14, 128, v8
    v_exp_f32 v2, v150
    v_add_f32 v21, v21, v1
    v_cvt_pk_bf16_f32 v250, v0, v1
    v_sub_f32 v152, v152, v22
    s_cmp_eq_u32 s55, 2
    s_cbranch_scc0 K1_D34
    s_add_u32 s52, s51, 81920
    s_add_u32 m0, s48, 49152
    s_nop 0
    buffer_load_dwordx4 v12, s[36:39], s52 offen nt lds
K1_D34:
    s_waitcnt lgkmcnt(3)
    v_mfma_f32_32x32x16_bf16 v[96:111], v[44:47], v[92:95], v[96:111]
    ds_read_b128 v[44:47], v27 offset:8192
    v_xor_b32 v15, 160, v8
    v_exp_f32 v3, v151
    v_add_f32 v20, v20, v2
    v_sub_f32 v153, v153, v22
    s_cmp_eq_u32 s55, 3
    s_cbranch_scc0 K1_D35
    s_add_u32 s52, s51, 81920
    s_add_u32 m0, s48, 49152
    s_nop 0
    buffer_load_dwordx4 v12, s[36:39], s52 offen nt lds
K1_D35:
    s_waitcnt lgkmcnt(3)
    v_mfma_f32_32x32x16_bf16 v[112:127], v[32:35], v[64:67], v[48:63]
    ds_read_b128 v[32:35], v28 offset:8192
    v_exp_f32 v0, v152
    v_add_f32 v21, v21, v3
    v_cvt_pk_bf16_f32 v251, v2, v3
    v_sub_f32 v154, v154, v22
    s_cmp_eq_u32 s55, 0
    s_cbranch_scc0 K1_D36
    s_add_u32 s52, s51, 81920
    s_add_u32 m0, s48, 50176
    s_nop 0
    buffer_load_dwordx4 v13, s[36:39], s52 offen nt lds
K1_D36:
    s_waitcnt lgkmcnt(3)
    v_mfma_f32_32x32x16_bf16 v[112:127], v[36:39], v[68:71], v[112:127]
    ds_read_b128 v[36:39], v29 offset:8192
    v_xor_b32 v4, 192, v8
    v_exp_f32 v1, v153
    v_add_f32 v20, v20, v0
    v_sub_f32 v155, v155, v22
    s_cmp_eq_u32 s55, 1
    s_cbranch_scc0 K1_D37
    s_add_u32 s52, s51, 81920
    s_add_u32 m0, s48, 50176
    s_nop 0
    buffer_load_dwordx4 v13, s[36:39], s52 offen nt lds
K1_D37:
    s_waitcnt lgkmcnt(3)
    v_mfma_f32_32x32x16_bf16 v[112:127], v[40:43], v[72:75], v[112:127]
    ds_read_b128 v[40:43], v30 offset:8192
    v_xor_b32 v5, 224, v8
    v_exp_f32 v2, v154
    v_add_f32 v21, v21, v1
    v_cvt_pk_bf16_f32 v252, v0, v1
    v_sub_f32 v156, v156, v22
    s_cmp_eq_u32 s55, 2
    s_cbranch_scc0 K1_D38
    s_add_u32 s52, s51, 81920
    s_add_u32 m0, s48, 50176
    s_nop 0
    buffer_load_dwordx4 v13, s[36:39], s52 offen nt lds
K1_D38:
    s_waitcnt lgkmcnt(3)
    v_mfma_f32_32x32x16_bf16 v[112:127], v[44:47], v[76:79], v[112:127]
    ds_read_b128 v[44:47], v31 offset:8192
    v_exp_f32 v3, v155
    v_add_f32 v20, v20, v2
    v_sub_f32 v157, v157, v22
    s_cmp_eq_u32 s55, 3
    s_cbranch_scc0 K1_D39
    s_add_u32 s52, s51, 81920
    s_add_u32 m0, s48, 50176
    s_nop 0
    buffer_load_dwordx4 v13, s[36:39], s52 offen nt lds
K1_D39:
    s_waitcnt lgkmcnt(3)
    v_mfma_f32_32x32x16_bf16 v[112:127], v[32:35], v[80:83], v[112:127]
    ds_read_b64_tr_b16 v[32:33], v8 offset:0
    ds_read_b64_tr_b16 v[34:35], v9 offset:2048
    v_exp_f32 v0, v156
    v_add_f32 v21, v21, v3
    v_cvt_pk_bf16_f32 v253, v2, v3
    v_sub_f32 v158, v158, v22
    s_cmp_eq_u32 s55, 0
    s_cbranch_scc0 K1_D40
    s_add_u32 s52, s51, 65536
    s_add_u32 m0, s48, 131072
    s_nop 0
    buffer_load_dwordx4 v12, s[40:43], s52 offen nt lds
K1_D40:
    s_waitcnt lgkmcnt(4)
    v_mfma_f32_32x32x16_bf16 v[112:127], v[36:39], v[84:87], v[112:127]
    ds_read_b64_tr_b16 v[36:37], v10 offset:0
    ds_read_b64_tr_b16 v[38:39], v11 offset:2048
    v_exp_f32 v1, v157
    v_add_f32 v20, v20, v0
    v_sub_f32 v159, v159, v22
    s_cmp_eq_u32 s55, 1
    s_cbranch_scc0 K1_D41
    s_add_u32 s52, s51, 65536
    s_add_u32 m0, s48, 131072
    s_nop 0
    buffer_load_dwordx4 v12, s[40:43], s52 offen nt lds
K1_D41:
    s_waitcnt lgkmcnt(5)
    v_mfma_f32_32x32x16_bf16 v[112:127], v[40:43], v[88:91], v[112:127]
    ds_read_b64_tr_b16 v[40:41], v14 offset:0
    ds_read_b64_tr_b16 v[42:43], v15 offset:2048
    v_exp_f32 v2, v158
    v_add_f32 v21, v21, v1
    v_cvt_pk_bf16_f32 v254, v0, v1
    v_exp_f32 v3, v159
    s_cmp_eq_u32 s55, 2
    s_cbranch_scc0 K1_D42
    s_add_u32 s52, s51, 65536
    s_add_u32 m0, s48, 131072
    s_nop 0
    buffer_load_dwordx4 v12, s[40:43], s52 offen nt lds
K1_D42:
    s_waitcnt lgkmcnt(6)
    v_mfma_f32_32x32x16_bf16 v[112:127], v[44:47], v[92:95], v[112:127]
    ds_read_b64_tr_b16 v[44:45], v4 offset:0
    ds_read_b64_tr_b16 v[46:47], v5 offset:2048
    v_add_f32 v20, v20, v2
    v_add_f32 v21, v21, v3
    v_cvt_pk_bf16_f32 v255, v2, v3
    s_cmp_eq_u32 s55, 3
    s_cbranch_scc0 K1_D43
    s_add_u32 s52, s51, 65536
    s_add_u32 m0, s48, 131072
    s_nop 0
    buffer_load_dwordx4 v12, s[40:43], s52 offen nt lds
K1_D43:
    v_add_f32 v20, v20, v21
    v_cmp_nge_f32 vcc, s56, v20
    s_nop 1
    s_cbranch_vccnz K1_SLOW1
K1_BACK1:
    v_add_f32 v18, v18, v20
    s_waitcnt lgkmcnt(6)
    v_mfma_f32_32x32x16_bf16 v[160:175], v[32:35], v[240:243], v[160:175]
    ds_read_b64_tr_b16 v[32:33], v8 offset:4096
    ds_read_b64_tr_b16 v[34:35], v9 offset:6144
    v_add_u32 v24, 81920, v16
    v_exp_f32 v0, v96
    v_exp_f32 v1, v97
    v_mov_b32 v20, v0
    s_cmp_eq_u32 s55, 0
    s_cbranch_scc0 K1_D44
    s_add_u32 s52, s51, 65536
    s_add_u32 m0, s48, 132096
    s_nop 0
    buffer_load_dwordx4 v13, s[40:43], s52 offen nt lds
K1_D44:
    s_waitcnt lgkmcnt(6)
    v_mfma_f32_32x32x16_bf16 v[176:191], v[36:39], v[240:243], v[176:191]
    ds_read_b64_tr_b16 v[36:37], v10 offset:4096
    ds_read_b64_tr_b16 v[38:39], v11 offset:6144
    v_xor_b32 v25, 32, v24
    v_exp_f32 v2, v98
    v_mov_b32 v21, v1
    s_cmp_eq_u32 s55, 1
    s_cbranch_scc0 K1_D45
    s_add_u32 s52, s51, 65536
    s_add_u32 m0, s48, 132096
    s_nop 0
    buffer_load_dwordx4 v13, s[40:43], s52 offen nt lds
K1_D45:
    s_waitcnt lgkmcnt(6)
    v_mfma_f32_32x32x16_bf16 v[192:207], v[40:43], v[240:243], v[192:207]
    ds_read_b64_tr_b16 v[40:41], v14 offset:4096
    ds_read_b64_tr_b16 v[42:43], v15 offset:6144
    v_cvt_pk_bf16_f32 v224, v0, v1
    v_exp_f32 v3, v99
    v_add_f32 v20, v20, v2
    s_cmp_eq_u32 s55, 2
    s_cbranch_scc0 K1_D46
    s_add_u32 s52, s51, 65536
    s_add_u32 m0, s48, 132096
    s_nop 0
    buffer_load_dwordx4 v13, s[40:43], s52 offen nt lds
K1_D46:
    s_waitcnt lgkmcnt(6)
    v_mfma_f32_32x32x16_bf16 v[208:223], v[44:47], v[240:243], v[208:223]
    ds_read_b64_tr_b16 v[44:45], v4 offset:4096
    ds_read_b64_tr_b16 v[46:47], v5 offset:6144
    v_xor_b32 v26, 64, v24
    v_exp_f32 v0, v100
    v_add_f32 v21, v21, v3
    s_cmp_eq_u32 s55, 3
    s_cbranch_scc0 K1_D47
    s_add_u32 s52, s51, 65536
    s_add_u32 m0, s48, 132096
    s_nop 0
    buffer_load_dwordx4 v13, s[40:43], s52 offen nt lds
K1_D47:
    s_waitcnt lgkmcnt(6)
    v_mfma_f32_32x32x16_bf16 v[160:175], v[32:35], v[244:247], v[160:175]
    ds_read_b64_tr_b16 v[32:33], v8 offset:8192
    ds_read_b64_tr_b16 v[34:35], v9 offset:10240
    v_xor_b32 v27, 96, v24
    v_cvt_pk_bf16_f32 v225, v2, v3
    v_exp_f32 v1, v101
    v_add_f32 v20, v20, v0
    s_cmp_eq_u32 s55, 0
    s_cbranch_scc0 K1_D48
    s_add_u32 s52, s51, 98304
    s_add_u32 m0, s48, 147456
    s_nop 0
    buffer_load_dwordx4 v12, s[36:39], s52 offen nt lds
K1_D48:
    s_waitcnt lgkmcnt(6)
    v_mfma_f32_32x32x16_bf16 v[176:191], v[36:39], v[244:247], v[176:191]
    ds_read_b64_tr_b16 v[36:37], v10 offset:8192
    ds_read_b64_tr_b16 v[38:39], v11 offset:10240
    v_exp_f32 v2, v102
    v_add_f32 v21, v21, v1
    s_cmp_eq_u32 s55, 1
    s_cbranch_scc0 K1_D49
    s_add_u32 s52, s51, 98304
    s_add_u32 m0, s48, 147456
    s_nop 0
    buffer_load_dwordx4 v12, s[36:39], s52 offen nt lds
K1_D49:
    s_waitcnt lgkmcnt(6)
    v_mfma_f32_32x32x16_bf16 v[192:207], v[40:43], v[244:247], v[192:207]
    ds_read_b64_tr_b16 v[40:41], v14 offset:8192
    ds_read_b64_tr_b16 v[42:43], v15 offset:10240
    v_xor_b32 v28, 128, v24
    v_cvt_pk_bf16_f32 v226, v0, v1
    v_exp_f32 v3, v103
    v_add_f32 v20, v20, v2
    s_cmp_eq_u32 s55, 2
    s_cbranch_scc0 K1_D50
    s_add_u32 s52, s51, 98304
    s_add_u32 m0, s48, 147456
    s_nop 0
    buffer_load_dwordx4 v12, s[36:39], s52 offen nt lds
K1_D50:
    s_waitcnt lgkmcnt(6)
    v_mfma_f32_32x32x16_bf16 v[208:223], v[44:47], v[244:247], v[208:223]
    ds_read_b64_tr_b16 v[44:45], v4 offset:8192
    ds_read_b64_tr_b16 v[46:47], v5 offset:10240
    v_xor_b32 v29, 160, v24
    v_exp_f32 v0, v104
    v_add_f32 v21, v21, v3
    s_cmp_eq_u32 s55, 3
    s_cbranch_scc0 K1_D51
    s_add_u32 s52, s51, 98304
    s_add_u32 m0, s48, 147456
    s_nop 0
    buffer_load_dwordx4 v12, s[36:39], s52 offen nt lds
K1_D51:
    s_waitcnt lgkmcnt(6)
    v_mfma_f32_32x32x16_bf16 v[160:175], v[32:35], v[248:251], v[160:175]
    ds_read_b64_tr_b16 v[32:33], v8 offset:12288
    ds_read_b64_tr_b16 v[34:35], v9 offset:14336
    v_cvt_pk_bf16_f32 v227, v2, v3
    v_exp_f32 v1, v105
    v_add_f32 v20, v20, v0
    s_cmp_eq_u32 s55, 0
    s_cbranch_scc0 K1_D52
    s_add_u32 s52, s51, 98304
    s_add_u32 m0, s48, 148480
    s_nop 0
    buffer_load_dwordx4 v13, s[36:39], s52 offen nt lds
K1_D52:
    s_waitcnt lgkmcnt(6)
    v_mfma_f32_32x32x16_bf16 v[176:191], v[36:39], v[248:251], v[176:191]
    ds_read_b64_tr_b16 v[36:37], v10 offset:12288
    ds_read_b64_tr_b16 v[38:39], v11 offset:14336
    v_xor_b32 v30, 192, v24
    v_exp_f32 v2, v106
    v_add_f32 v21, v21, v1
    s_cmp_eq_u32 s55, 1
    s_cbranch_scc0 K1_D53
    s_add_u32 s52, s51, 98304
    s_add_u32 m0, s48, 148480
    s_nop 0
    buffer_load_dwordx4 v13, s[36:39], s52 offen nt lds
K1_D53:
    s_waitcnt lgkmcnt(6)
    v_mfma_f32_32x32x16_bf16 v[192:207], v[40:43], v[248:251], v[192:207]
    ds_read_b64_tr_b16 v[40:41], v14 offset:12288
    ds_read_b64_tr_b16 v[42:43], v15 offset:14336
    v_xor_b32 v31, 224, v24
    v_cvt_pk_bf16_f32 v228, v0, v1
    v_exp_f32 v3, v107
    v_add_f32 v20, v20, v2
    s_cmp_eq_u32 s55, 2
    s_cbranch_scc0 K1_D54
    s_add_u32 s52, s51, 98304
    s_add_u32 m0, s48, 148480
    s_nop 0
    buffer_load_dwordx4 v13, s[36:39], s52 offen nt lds
K1_D54:
    s_waitcnt lgkmcnt(6)
    v_mfma_f32_32x32x16_bf16 v[208:223], v[44:47], v[248:251], v[208:223]
    ds_read_b64_tr_b16 v[44:45], v4 offset:12288
    ds_read_b64_tr_b16 v[46:47], v5 offset:14336
    v_exp_f32 v0, v108
    v_add_f32 v21, v21, v3
    s_cmp_eq_u32 s55, 3
    s_cbranch_scc0 K1_D55
    s_add_u32 s52, s51, 98304
    s_add_u32 m0, s48, 148480
    s_nop 0
    buffer_load_dwordx4 v13, s[36:39], s52 offen nt lds
K1_D55:
    s_waitcnt lgkmcnt(6)
    v_mfma_f32_32x32x16_bf16 v[160:175], v[32:35], v[252:255], v[160:175]
    s_cmp_eq_u32 s55, 0
    s_cbranch_scc0 K1_D56
    s_add_u32 s52, s51, 81920
    s_add_u32 m0, s48, 0
    s_nop 0
    buffer_load_dwordx4 v12, s[40:43], s52 offen nt lds
K1_D56:
    s_cmp_eq_u32 s55, 1
    s_cbranch_scc0 K1_D57
    s_add_u32 s52, s51, 81920
    s_add_u32 m0, s48, 0
    s_nop 0
    buffer_load_dwordx4 v12, s[40:43], s52 offen nt lds
K1_D57:
    s_cmp_eq_u32 s55, 2
    s_cbranch_scc0 K1_D58
    s_add_u32 s52, s51, 81920
    s_add_u32 m0, s48, 0
    s_nop 0
    buffer_load_dwordx4 v12, s[40:43], s52 offen nt lds
K1_D58:
    s_cmp_eq_u32 s55, 3
    s_cbranch_scc0 K1_D59
    s_add_u32 s52, s51, 81920
    s_add_u32 m0, s48, 0
    s_nop 0
    buffer_load_dwordx4 v12, s[40:43], s52 offen nt lds
K1_D59:
    s_cmp_eq_u32 s55, 0
    s_cbranch_scc0 K1_D60
    s_add_u32 s52, s51, 81920
    s_add_u32 m0, s48, 1024
    s_nop 0
    buffer_load_dwordx4 v13, s[40:43], s52 offen nt lds
K1_D60:
    s_cmp_eq_u32 s55, 1
    s_cbranch_scc0 K1_D61
    s_add_u32 s52, s51, 81920
    s_add_u32 m0, s48, 1024
    s_nop 0
    buffer_load_dwordx4 v13, s[40:43], s52 offen nt lds
K1_D61:
    s_cmp_eq_u32 s55, 2
    s_cbranch_scc0 K1_D62
    s_add_u32 s52, s51, 81920
    s_add_u32 m0, s48, 1024
    s_nop 0
    buffer_load_dwordx4 v13, s[40:43], s52 offen nt lds
K1_D62:
    s_cmp_eq_u32 s55, 3
    s_cbranch_scc0 K1_D63
    s_add_u32 s52, s51, 81920
    s_add_u32 m0, s48, 1024
    s_nop 0
    buffer_load_dwordx4 v13, s[40:43], s52 offen nt lds
K1_D63:
    s_waitcnt lgkmcnt(0)
    s_waitcnt vmcnt(12)
    s_barrier
    s_load_dwordx2 s[8:9], s[0:1], 32
    s_load_dwordx2 s[10:11], s[0:1], 72
    s_load_dwordx2 s[12:13], s[0:1], 80
    s_load_dwordx2 s[14:15], s[0:1], 88
    ds_read_b128 v[32:35], v24 offset:0
    v_cvt_pk_bf16_f32 v229, v2, v3
    v_exp_f32 v1, v109
    v_add_f32 v20, v20, v0
    s_cmp_eq_u32 s55, 0
    s_cbranch_scc0 K1_D64
    s_add_u32 s52, s51, 114688
    s_add_u32 m0, s48, 16384
    s_nop 0
    buffer_load_dwordx4 v12, s[36:39], s52 offen nt lds
K1_D64:
    v_mfma_f32_32x32x16_bf16 v[176:191], v[36:39], v[252:255], v[176:191]
    ds_read_b128 v[36:39], v25 offset:0
    v_exp_f32 v2, v110
    v_add_f32 v21, v21, v1
    s_cmp_eq_u32 s55, 1
    s_cbranch_scc0 K1_D65
    s_add_u32 s52, s51, 114688
    s_add_u32 m0, s48, 16384
    s_nop 0
    buffer_load_dwordx4 v12, s[36:39], s52 offen nt lds
K1_D65:
    v_mfma_f32_32x32x16_bf16 v[192:207], v[40:43], v[252:255], v[192:207]
    ds_read_b128 v[40:43], v26 offset:0
    v_cvt_pk_bf16_f32 v230, v0, v1
    v_exp_f32 v3, v111
    v_add_f32 v20, v20, v2
    s_cmp_eq_u32 s55, 2
    s_cbranch_scc0 K1_D66
    s_add_u32 s52, s51, 114688
    s_add_u32 m0, s48, 16384
    s_nop 0
    buffer_load_dwordx4 v12, s[36:39], s52 offen nt lds
K1_D66:
    v_mfma_f32_32x32x16_bf16 v[208:223], v[44:47], v[252:255], v[208:223]
    ds_read_b128 v[44:47], v27 offset:0
    v_add_f32 v21, v21, v3
    v_cvt_pk_bf16_f32 v231, v2, v3
    s_cmp_eq_u32 s55, 3
    s_cbranch_scc0 K1_D67
    s_add_u32 s52, s51, 114688
    s_add_u32 m0, s48, 16384
    s_nop 0
    buffer_load_dwordx4 v12, s[36:39], s52 offen nt lds
K1_D67:
    s_waitcnt lgkmcnt(3)
    v_mfma_f32_32x32x16_bf16 v[128:143], v[32:35], v[64:67], v[48:63]
    ds_read_b128 v[32:35], v28 offset:0
    v_add_u32 v8, 98304, v17
    v_exp_f32 v0, v112
    v_exp_f32 v1, v113
    v_add_f32 v20, v20, v0
    s_cmp_eq_u32 s55, 0
    s_cbranch_scc0 K1_D68
    s_add_u32 s52, s51, 114688
    s_add_u32 m0, s48, 17408
    s_nop 0
    buffer_load_dwordx4 v13, s[36:39], s52 offen nt lds
K1_D68:
    s_waitcnt lgkmcnt(3)
    v_mfma_f32_32x32x16_bf16 v[128:143], v[36:39], v[68:71], v[128:143]
    ds_read_b128 v[36:39], v29 offset:0
    v_xor_b32 v9, 32, v8
    v_exp_f32 v2, v114
    v_add_f32 v21, v21, v1
    s_cmp_eq_u32 s55, 1
    s_cbranch_scc0 K1_D69
    s_add_u32 s52, s51, 114688
    s_add_u32 m0, s48, 17408
    s_nop 0
    buffer_load_dwordx4 v13, s[36:39], s52 offen nt lds
K1_D69:
    s_waitcnt lgkmcnt(3)
    v_mfma_f32_32x32x16_bf16 v[128:143], v[40:43], v[72:75], v[128:143]
    ds_read_b128 v[40:43], v30 offset:0
    v_cvt_pk_bf16_f32 v232, v0, v1
    v_exp_f32 v3, v115
    v_add_f32 v20, v20, v2
    s_cmp_eq_u32 s55, 2
    s_cbranch_scc0 K1_D70
    s_add_u32 s52, s51, 114688
    s_add_u32 m0, s48, 17408
    s_nop 0
    buffer_load_dwordx4 v13, s[36:39], s52 offen nt lds
K1_D70:
    s_waitcnt lgkmcnt(3)
    v_mfma_f32_32x32x16_bf16 v[128:143], v[44:47], v[76:79], v[128:143]
    ds_read_b128 v[44:47], v31 offset:0
    v_xor_b32 v10, 64, v8
    v_exp_f32 v0, v116
    v_add_f32 v21, v21, v3
    s_cmp_eq_u32 s55, 3
    s_cbranch_scc0 K1_D71
    s_add_u32 s52, s51, 114688
    s_add_u32 m0, s48, 17408
    s_nop 0
    buffer_load_dwordx4 v13, s[36:39], s52 offen nt lds
K1_D71:
    s_waitcnt lgkmcnt(3)
    v_mfma_f32_32x32x16_bf16 v[128:143], v[32:35], v[80:83], v[128:143]
    ds_read_b128 v[32:35], v24 offset:8192
    v_xor_b32 v11, 96, v8
    v_cvt_pk_bf16_f32 v233, v2, v3
    v_exp_f32 v1, v117
    v_add_f32 v20, v20, v0
    s_cmp_eq_u32 s55, 0
    s_cbranch_scc0 K1_D72
    s_add_u32 s52, s51, 98304
    s_add_u32 m0, s48, 65536
    s_nop 0
    buffer_load_dwordx4 v12, s[40:43], s52 offen nt lds
K1_D72:
    s_waitcnt lgkmcnt(3)
    v_mfma_f32_32x32x16_bf16 v[128:143], v[36:39], v[84:87], v[128:143]
    ds_read_b128 v[36:39], v25 offset:8192
    v_exp_f32 v2, v118
    v_add_f32 v21, v21, v1
    s_cmp_eq_u32 s55, 1
    s_cbranch_scc0 K1_D73
    s_add_u32 s52, s51, 98304
    s_add_u32 m0, s48, 65536
    s_nop 0
    buffer_load_dwordx4 v12, s[40:43], s52 offen nt lds
K1_D73:
    s_waitcnt lgkmcnt(3)
    v_mfma_f32_32x32x16_bf16 v[128:143], v[40:43], v[88:91], v[128:143]
    ds_read_b128 v[40:43], v26 offset:8192
    v_xor_b32 v14, 128, v8
    v_cvt_pk_bf16_f32 v234, v0, v1
    v_exp_f32 v3, v119
    v_add_f32 v20, v20, v2
    s_cmp_eq_u32 s55, 2
    s_cbranch_scc0 K1_D74
    s_add_u32 s52, s51, 98304
    s_add_u32 m0, s48, 65536
    s_nop 0
    buffer_load_dwordx4 v12, s[40:43], s52 offen nt lds
K1_D74:
    s_waitcnt lgkmcnt(3)
    v_mfma_f32_32x32x16_bf16 v[128:143], v[44:47], v[92:95], v[128:143]
    ds_read_b128 v[44:47], v27 offset:8192
    v_xor_b32 v15, 160, v8
    v_exp_f32 v0, v120
    v_add_f32 v21, v21, v3
    s_cmp_eq_u32 s55, 3
    s_cbranch_scc0 K1_D75
    s_add_u32 s52, s51, 98304
    s_add_u32 m0, s48, 65536
    s_nop 0
    buffer_load_dwordx4 v12, s[40:43], s52 offen nt lds
K1_D75:
    s_waitcnt lgkmcnt(3)
    v_mfma_f32_32x32x16_bf16 v[144:159], v[32:35], v[64:67], v[48:63]
    ds_read_b128 v[32:35], v28 offset:8192
    v_cvt_pk_bf16_f32 v235, v2, v3
    v_exp_f32 v1, v121
    v_add_f32 v20, v20, v0
    s_cmp_eq_u32 s55, 0
    s_cbranch_scc0 K1_D76
    s_add_u32 s52, s51, 98304
    s_add_u32 m0, s48, 66560
    s_nop 0
    buffer_load_dwordx4 v13, s[40:43], s52 offen nt lds
K1_D76:
    s_waitcnt lgkmcnt(3)
    v_mfma_f32_32x32x16_bf16 v[144:159], v[36:39], v[68:71], v[144:159]
    ds_read_b128 v[36:39], v29 offset:8192
    v_xor_b32 v4, 192, v8
    v_exp_f32 v2, v122
    v_add_f32 v21, v21, v1
    s_cmp_eq_u32 s55, 1
    s_cbranch_scc0 K1_D77
    s_add_u32 s52, s51, 98304
    s_add_u32 m0, s48, 66560
    s_nop 0
    buffer_load_dwordx4 v13, s[40:43], s52 offen nt lds
K1_D77:
    s_waitcnt lgkmcnt(3)
    v_mfma_f32_32x32x16_bf16 v[144:159], v[40:43], v[72:75], v[144:159]
    ds_read_b128 v[40:43], v30 offset:8192
    v_xor_b32 v5, 224, v8
    v_cvt_pk_bf16_f32 v236, v0, v1
    v_exp_f32 v3, v123
    v_add_f32 v20, v20, v2
    s_cmp_eq_u32 s55, 2
    s_cbranch_scc0 K1_D78
    s_add_u32 s52, s51, 98304
    s_add_u32 m0, s48, 66560
    s_nop 0
    buffer_load_dwordx4 v13, s[40:43], s52 offen nt lds
K1_D78:
    s_waitcnt lgkmcnt(3)
    v_mfma_f32_32x32x16_bf16 v[144:159], v[44:47], v[76:79], v[144:159]
    ds_read_b128 v[44:47], v31 offset:8192
    v_exp_f32 v0, v124
    v_add_f32 v21, v21, v3
    s_cmp_eq_u32 s55, 3
    s_cbranch_scc0 K1_D79
    s_add_u32 s52, s51, 98304
    s_add_u32 m0, s48, 66560
    s_nop 0
    buffer_load_dwordx4 v13, s[40:43], s52 offen nt lds
K1_D79:
    s_waitcnt lgkmcnt(3)
    v_mfma_f32_32x32x16_bf16 v[144:159], v[32:35], v[80:83], v[144:159]
    ds_read_b64_tr_b16 v[32:33], v8 offset:0
    ds_read_b64_tr_b16 v[34:35], v9 offset:2048
    v_cvt_pk_bf16_f32 v237, v2, v3
    v_exp_f32 v1, v125
    v_add_f32 v20, v20, v0
    s_waitcnt lgkmcnt(4)
    v_mfma_f32_32x32x16_bf16 v[144:159], v[36:39], v[84:87], v[144:159]
    ds_read_b64_tr_b16 v[36:37], v10 offset:0
    ds_read_b64_tr_b16 v[38:39], v11 offset:2048
    v_exp_f32 v2, v126
    v_add_f32 v21, v21, v1
    s_waitcnt lgkmcnt(5)
    v_mfma_f32_32x32x16_bf16 v[144:159], v[40:43], v[88:91], v[144:159]
    ds_read_b64_tr_b16 v[40:41], v14 offset:0
    ds_read_b64_tr_b16 v[42:43], v15 offset:2048
    v_cvt_pk_bf16_f32 v238, v0, v1
    v_exp_f32 v3, v127
    v_add_f32 v20, v20, v2
    s_waitcnt lgkmcnt(6)
    v_mfma_f32_32x32x16_bf16 v[144:159], v[44:47], v[92:95], v[144:159]
    ds_read_b64_tr_b16 v[44:45], v4 offset:0
    ds_read_b64_tr_b16 v[46:47], v5 offset:2048
    v_add_f32 v21, v21, v3
    v_cvt_pk_bf16_f32 v239, v2, v3
    v_add_f32 v20, v20, v21
    v_cmp_nge_f32 vcc, s56, v20
    s_nop 1
    s_cbranch_vccnz K1_SLOW2
K1_BACK2:
    v_add_f32 v18, v18, v20
    s_waitcnt lgkmcnt(6)
    v_mfma_f32_32x32x16_bf16 v[160:175], v[32:35], v[224:227], v[160:175]
    ds_read_b64_tr_b16 v[32:33], v8 offset:4096
    ds_read_b64_tr_b16 v[34:35], v9 offset:6144
    v_add_u32 v24, 114688, v16
    v_exp_f32 v0, v128
    v_exp_f32 v1, v129
    v_mov_b32 v20, v0
    s_waitcnt lgkmcnt(6)
    v_mfma_f32_32x32x16_bf16 v[176:191], v[36:39], v[224:227], v[176:191]
    ds_read_b64_tr_b16 v[36:37], v10 offset:4096
    ds_read_b64_tr_b16 v[38:39], v11 offset:6144
    v_xor_b32 v25, 32, v24
    v_exp_f32 v2, v130
    v_mov_b32 v21, v1
    s_waitcnt lgkmcnt(6)
    v_mfma_f32_32x32x16_bf16 v[192:207], v[40:43], v[224:227], v[192:207]
    ds_read_b64_tr_b16 v[40:41], v14 offset:4096
    ds_read_b64_tr_b16 v[42:43], v15 offset:6144
    v_cvt_pk_bf16_f32 v240, v0, v1
    v_exp_f32 v3, v131
    v_add_f32 v20, v20, v2
    s_waitcnt lgkmcnt(6)
    v_mfma_f32_32x32x16_bf16 v[208:223], v[44:47], v[224:227], v[208:223]
    ds_read_b64_tr_b16 v[44:45], v4 offset:4096
    ds_read_b64_tr_b16 v[46:47], v5 offset:6144
    v_xor_b32 v26, 64, v24
    v_exp_f32 v0, v132
    v_add_f32 v21, v21, v3
    s_waitcnt lgkmcnt(6)
    v_mfma_f32_32x32x16_bf16 v[160:175], v[32:35], v[228:231], v[160:175]
    ds_read_b64_tr_b16 v[32:33], v8 offset:8192
    ds_read_b64_tr_b16 v[34:35], v9 offset:10240
    v_xor_b32 v27, 96, v24
    v_cvt_pk_bf16_f32 v241, v2, v3
    v_exp_f32 v1, v133
    v_add_f32 v20, v20, v0
    s_waitcnt lgkmcnt(6)
    v_mfma_f32_32x32x16_bf16 v[176:191], v[36:39], v[228:231], v[176:191]
    ds_read_b64_tr_b16 v[36:37], v10 offset:8192
    ds_read_b64_tr_b16 v[38:39], v11 offset:10240
    v_exp_f32 v2, v134
    v_add_f32 v21, v21, v1
    s_waitcnt lgkmcnt(6)
    v_mfma_f32_32x32x16_bf16 v[192:207], v[40:43], v[228:231], v[192:207]
    ds_read_b64_tr_b16 v[40:41], v14 offset:8192
    ds_read_b64_tr_b16 v[42:43], v15 offset:10240
    v_xor_b32 v28, 128, v24
    v_cvt_pk_bf16_f32 v242, v0, v1
    v_exp_f32 v3, v135
    v_add_f32 v20, v20, v2
    s_waitcnt lgkmcnt(6)
    v_mfma_f32_32x32x16_bf16 v[208:223], v[44:47], v[228:231], v[208:223]
    ds_read_b64_tr_b16 v[44:45], v4 offset:8192
    ds_read_b64_tr_b16 v[46:47], v5 offset:10240
    v_xor_b32 v29, 160, v24
    v_exp_f32 v0, v136
    v_add_f32 v21, v21, v3
    s_waitcnt lgkmcnt(6)
    v_mfma_f32_32x32x16_bf16 v[160:175], v[32:35], v[232:235], v[160:175]
    ds_read_b64_tr_b16 v[32:33], v8 offset:12288
    ds_read_b64_tr_b16 v[34:35], v9 offset:14336
    v_cvt_pk_bf16_f32 v243, v2, v3
    v_exp_f32 v1, v137
    v_add_f32 v20, v20, v0
    s_waitcnt lgkmcnt(6)
    v_mfma_f32_32x32x16_bf16 v[176:191], v[36:39], v[232:235], v[176:191]
    ds_read_b64_tr_b16 v[36:37], v10 offset:12288
    ds_read_b64_tr_b16 v[38:39], v11 offset:14336
    v_xor_b32 v30, 192, v24
    v_exp_f32 v2, v138
    v_add_f32 v21, v21, v1
    s_waitcnt lgkmcnt(6)
    v_mfma_f32_32x32x16_bf16 v[192:207], v[40:43], v[232:235], v[192:207]
    ds_read_b64_tr_b16 v[40:41], v14 offset:12288
    ds_read_b64_tr_b16 v[42:43], v15 offset:14336
    v_xor_b32 v31, 224, v24
    v_cvt_pk_bf16_f32 v244, v0, v1
    v_exp_f32 v3, v139
    v_add_f32 v20, v20, v2
    s_waitcnt lgkmcnt(6)
    v_mfma_f32_32x32x16_bf16 v[208:223], v[44:47], v[232:235], v[208:223]
    ds_read_b64_tr_b16 v[44:45], v4 offset:12288
    ds_read_b64_tr_b16 v[46:47], v5 offset:14336
    v_exp_f32 v0, v140
    v_add_f32 v21, v21, v3
    s_waitcnt lgkmcnt(6)
    v_mfma_f32_32x32x16_bf16 v[160:175], v[32:35], v[236:239], v[160:175]
    s_waitcnt lgkmcnt(0)
    s_waitcnt vmcnt(12)
    s_barrier
    s_waitcnt lgkmcnt(0)
    s_and_b32 s3, s2, 7
    s_lshl_b32 s3, s3, 5
    s_lshr_b32 s17, s2, 3
    s_add_u32 s17, s3, s17
    s_min_u32 s3, s17, 251
    s_cmp_ge_u32 s3, 126
    s_cselect_b32 s16, 1, 0
    s_cselect_b32 s8, s10, s8
    s_cselect_b32 s9, s11, s9
    s_mov_b32 s28, s8
    s_and_b32 s29, s9, 0xffff
    s_mov_b32 s30, 4718592
    s_mov_b32 s31, 0x00020000
    s_mov_b32 s32, s12
    s_and_b32 s33, s13, 0xffff
    s_mov_b32 s34, 2064384
    s_mov_b32 s35, 0x00020000
    s_mov_b32 s20, s14
    s_and_b32 s21, s15, 0xffff
    s_mov_b32 s22, 256
    s_mov_b32 s23, 0x00020000
    s_mul_i32 s12, s16, 126
    s_sub_u32 s3, s3, s12
    s_mul_i32 s12, s3, 57
    s_lshr_b32 s18, s12, 9
    s_mul_i32 s12, s18, 9
    s_sub_u32 s19, s3, s12
    s_mul_i32 s50, s5, 589824
    s_lshl_b32 s12, s19, 7
    s_add_u32 s50, s50, s12
    s_mul_i32 s8, s16, 7340032
    s_lshl_b32 s12, s18, 19
    s_add_u32 s8, s8, s12
    s_lshl_b32 s12, s5, 14
    s_add_u32 s8, s8, s12
    s_add_u32 s9, s8, 262144
    s_lshl_b32 s12, s16, 6
    s_add_u32 s12, s12, 128
    s_mul_i32 s13, s18, 148
    s_lshr_b32 s10, s13, 8
    s_lshl_b32 s10, s10, 2
    s_add_u32 s10, s10, s12
    s_add_u32 s13, s13, 111
    s_lshr_b32 s11, s13, 8
    s_lshl_b32 s11, s11, 2
    s_add_u32 s11, s11, s12
    ds_read_b128 v[32:35], v24 offset:0
    v_cvt_pk_bf16_f32 v245, v2, v3
    v_exp_f32 v1, v141
    v_add_f32 v20, v20, v0
    s_cmp_eq_u32 s55, 0
    s_cbranch_scc0 K1_D80
    s_add_u32 s52, s51, 114688
    s_add_u32 m0, s48, 81920
    s_nop 0
    buffer_load_dwordx4 v12, s[40:43], s52 offen nt lds
K1_D80:
    v_mfma_f32_32x32x16_bf16 v[176:191], v[36:39], v[236:239], v[176:191]
    ds_read_b128 v[36:39], v25 offset:0
    v_exp_f32 v2, v142
    v_add_f32 v21, v21, v1
    s_cmp_eq_u32 s55, 1
    s_cbranch_scc0 K1_D81
    s_add_u32 s52, s51, 114688
    s_add_u32 m0, s48, 81920
    s_nop 0
    buffer_load_dwordx4 v12, s[40:43], s52 offen nt lds
K1_D81:
    v_mfma_f32_32x32x16_bf16 v[192:207], v[40:43], v[236:239], v[192:207]
    ds_read_b128 v[40:43], v26 offset:0
    v_cvt_pk_bf16_f32 v246, v0, v1
    v_exp_f32 v3, v143
    v_add_f32 v20, v20, v2
    s_cmp_eq_u32 s55, 2
    s_cbranch_scc0 K1_D82
    s_add_u32 s52, s51, 114688
    s_add_u32 m0, s48, 81920
    s_nop 0
    buffer_load_dwordx4 v12, s[40:43], s52 offen nt lds
K1_D82:
    v_mfma_f32_32x32x16_bf16 v[208:223], v[44:47], v[236:239], v[208:223]
    ds_read_b128 v[44:47], v27 offset:0
    v_add_f32 v21, v21, v3
    v_cvt_pk_bf16_f32 v247, v2, v3
    s_cmp_eq_u32 s55, 3
    s_cbranch_scc0 K1_D83
    s_add_u32 s52, s51, 114688
    s_add_u32 m0, s48, 81920
    s_nop 0
    buffer_load_dwordx4 v12, s[40:43], s52 offen nt lds
K1_D83:
    s_waitcnt lgkmcnt(3)
    v_mfma_f32_32x32x16_bf16 v[96:111], v[32:35], v[64:67], v[48:63]
    ds_read_b128 v[32:35], v28 offset:0
    v_add_u32 v8, 32768, v17
    v_exp_f32 v0, v144
    v_exp_f32 v1, v145
    v_add_f32 v20, v20, v0
    s_cmp_eq_u32 s55, 0
    s_cbranch_scc0 K1_D84
    s_add_u32 s52, s51, 114688
    s_add_u32 m0, s48, 82944
    s_nop 0
    buffer_load_dwordx4 v13, s[40:43], s52 offen nt lds
K1_D84:
    s_waitcnt lgkmcnt(3)
    v_mfma_f32_32x32x16_bf16 v[96:111], v[36:39], v[68:71], v[96:111]
    ds_read_b128 v[36:39], v29 offset:0
    v_xor_b32 v9, 32, v8
    v_exp_f32 v2, v146
    v_add_f32 v21, v21, v1
    s_cmp_eq_u32 s55, 1
    s_cbranch_scc0 K1_D85
    s_add_u32 s52, s51, 114688
    s_add_u32 m0, s48, 82944
    s_nop 0
    buffer_load_dwordx4 v13, s[40:43], s52 offen nt lds
K1_D85:
    s_waitcnt lgkmcnt(3)
    v_mfma_f32_32x32x16_bf16 v[96:111], v[40:43], v[72:75], v[96:111]
    ds_read_b128 v[40:43], v30 offset:0
    v_cvt_pk_bf16_f32 v248, v0, v1
    v_exp_f32 v3, v147
    v_add_f32 v20, v20, v2
    s_cmp_eq_u32 s55, 2
    s_cbranch_scc0 K1_D86
    s_add_u32 s52, s51, 114688
    s_add_u32 m0, s48, 82944
    s_nop 0
    buffer_load_dwordx4 v13, s[40:43], s52 offen nt lds
K1_D86:
    s_waitcnt lgkmcnt(3)
    v_mfma_f32_32x32x16_bf16 v[96:111], v[44:47], v[76:79], v[96:111]
    ds_read_b128 v[44:47], v31 offset:0
    v_xor_b32 v10, 64, v8
    v_exp_f32 v0, v148
    v_add_f32 v21, v21, v3
    s_cmp_eq_u32 s55, 3
    s_cbranch_scc0 K1_D87
    s_add_u32 s52, s51, 114688
    s_add_u32 m0, s48, 82944
    s_nop 0
    buffer_load_dwordx4 v13, s[40:43], s52 offen nt lds
K1_D87:
    s_waitcnt lgkmcnt(3)
    v_mfma_f32_32x32x16_bf16 v[96:111], v[32:35], v[80:83], v[96:111]
    ds_read_b128 v[32:35], v24 offset:8192
    v_xor_b32 v11, 96, v8
    v_cvt_pk_bf16_f32 v249, v2, v3
    v_exp_f32 v1, v149
    v_add_f32 v20, v20, v0
    s_waitcnt lgkmcnt(3)
    v_mfma_f32_32x32x16_bf16 v[96:111], v[36:39], v[84:87], v[96:111]
    ds_read_b128 v[36:39], v25 offset:8192
    v_exp_f32 v2, v150
    v_add_f32 v21, v21, v1
    s_waitcnt lgkmcnt(3)
    v_mfma_f32_32x32x16_bf16 v[96:111], v[40:43], v[88:91], v[96:111]
    ds_read_b128 v[40:43], v26 offset:8192
    v_xor_b32 v14, 128, v8
    v_cvt_pk_bf16_f32 v250, v0, v1
    v_exp_f32 v3, v151
    v_add_f32 v20, v20, v2
    s_waitcnt lgkmcnt(3)
    v_mfma_f32_32x32x16_bf16 v[96:111], v[44:47], v[92:95], v[96:111]
    ds_read_b128 v[44:47], v27 offset:8192
    v_xor_b32 v15, 160, v8
    v_exp_f32 v0, v152
    v_add_f32 v21, v21, v3
    s_waitcnt lgkmcnt(3)
    v_mfma_f32_32x32x16_bf16 v[112:127], v[32:35], v[64:67], v[48:63]
    ds_read_b128 v[32:35], v28 offset:8192
    v_cvt_pk_bf16_f32 v251, v2, v3
    v_exp_f32 v1, v153
    v_add_f32 v20, v20, v0
    s_waitcnt lgkmcnt(3)
    v_mfma_f32_32x32x16_bf16 v[112:127], v[36:39], v[68:71], v[112:127]
    ds_read_b128 v[36:39], v29 offset:8192
    v_xor_b32 v4, 192, v8
    v_exp_f32 v2, v154
    v_add_f32 v21, v21, v1
    s_waitcnt lgkmcnt(3)
    v_mfma_f32_32x32x16_bf16 v[112:127], v[40:43], v[72:75], v[112:127]
    ds_read_b128 v[40:43], v30 offset:8192
    v_xor_b32 v5, 224, v8
    v_cvt_pk_bf16_f32 v252, v0, v1
    v_exp_f32 v3, v155
    v_add_f32 v20, v20, v2
    s_waitcnt lgkmcnt(3)
    v_mfma_f32_32x32x16_bf16 v[112:127], v[44:47], v[76:79], v[112:127]
    ds_read_b128 v[44:47], v31 offset:8192
    v_exp_f32 v0, v156
    v_add_f32 v21, v21, v3
    s_waitcnt lgkmcnt(3)
    v_mfma_f32_32x32x16_bf16 v[112:127], v[32:35], v[80:83], v[112:127]
    ds_read_b64_tr_b16 v[32:33], v8 offset:0
    ds_read_b64_tr_b16 v[34:35], v9 offset:2048
    v_cvt_pk_bf16_f32 v253, v2, v3
    v_exp_f32 v1, v157
    v_add_f32 v20, v20, v0
    s_waitcnt lgkmcnt(4)
    v_mfma_f32_32x32x16_bf16 v[112:127], v[36:39], v[84:87], v[112:127]
    ds_read_b64_tr_b16 v[36:37], v10 offset:0
    ds_read_b64_tr_b16 v[38:39], v11 offset:2048
    v_exp_f32 v2, v158
    v_add_f32 v21, v21, v1
    s_waitcnt lgkmcnt(5)
    v_mfma_f32_32x32x16_bf16 v[112:127], v[40:43], v[88:91], v[112:127]
    ds_read_b64_tr_b16 v[40:41], v14 offset:0
    ds_read_b64_tr_b16 v[42:43], v15 offset:2048
    v_cvt_pk_bf16_f32 v254, v0, v1
    v_exp_f32 v3, v159
    v_add_f32 v20, v20, v2
    s_waitcnt lgkmcnt(6)
    v_mfma_f32_32x32x16_bf16 v[112:127], v[44:47], v[92:95], v[112:127]
    ds_read_b64_tr_b16 v[44:45], v4 offset:0
    ds_read_b64_tr_b16 v[46:47], v5 offset:2048
    v_add_f32 v21, v21, v3
    v_cvt_pk_bf16_f32 v255, v2, v3
    v_add_f32 v20, v20, v21
    v_cmp_nge_f32 vcc, s56, v20
    s_nop 1
    s_cbranch_vccnz K1_SLOW3
K1_BACK3:
    v_add_f32 v18, v18, v20
    s_waitcnt lgkmcnt(6)
    v_mfma_f32_32x32x16_bf16 v[160:175], v[32:35], v[240:243], v[160:175]
    ds_read_b64_tr_b16 v[32:33], v8 offset:4096
    ds_read_b64_tr_b16 v[34:35], v9 offset:6144
    v_add_u32 v24, 49152, v16
    v_exp_f32 v0, v96
    v_exp_f32 v1, v97
    v_mov_b32 v20, v0
    s_waitcnt lgkmcnt(6)
    v_mfma_f32_32x32x16_bf16 v[176:191], v[36:39], v[240:243], v[176:191]
    ds_read_b64_tr_b16 v[36:37], v10 offset:4096
    ds_read_b64_tr_b16 v[38:39], v11 offset:6144
    v_xor_b32 v25, 32, v24
    v_exp_f32 v2, v98
    v_mov_b32 v21, v1
    s_waitcnt lgkmcnt(6)
    v_mfma_f32_32x32x16_bf16 v[192:207], v[40:43], v[240:243], v[192:207]
    ds_read_b64_tr_b16 v[40:41], v14 offset:4096
    ds_read_b64_tr_b16 v[42:43], v15 offset:6144
    v_cvt_pk_bf16_f32 v224, v0, v1
    v_exp_f32 v3, v99
    v_add_f32 v20, v20, v2
    s_waitcnt lgkmcnt(6)
    v_mfma_f32_32x32x16_bf16 v[208:223], v[44:47], v[240:243], v[208:223]
    ds_read_b64_tr_b16 v[44:45], v4 offset:4096
    ds_read_b64_tr_b16 v[46:47], v5 offset:6144
    v_xor_b32 v26, 64, v24
    v_exp_f32 v0, v100
    v_add_f32 v21, v21, v3
    s_waitcnt lgkmcnt(6)
    v_mfma_f32_32x32x16_bf16 v[160:175], v[32:35], v[244:247], v[160:175]
    ds_read_b64_tr_b16 v[32:33], v8 offset:8192
    ds_read_b64_tr_b16 v[34:35], v9 offset:10240
    v_xor_b32 v27, 96, v24
    v_cvt_pk_bf16_f32 v225, v2, v3
    v_exp_f32 v1, v101
    v_add_f32 v20, v20, v0
    s_waitcnt lgkmcnt(6)
    v_mfma_f32_32x32x16_bf16 v[176:191], v[36:39], v[244:247], v[176:191]
    ds_read_b64_tr_b16 v[36:37], v10 offset:8192
    ds_read_b64_tr_b16 v[38:39], v11 offset:10240
    v_exp_f32 v2, v102
    v_add_f32 v21, v21, v1
    s_waitcnt lgkmcnt(6)
    v_mfma_f32_32x32x16_bf16 v[192:207], v[40:43], v[244:247], v[192:207]
    ds_read_b64_tr_b16 v[40:41], v14 offset:8192
    ds_read_b64_tr_b16 v[42:43], v15 offset:10240
    v_xor_b32 v28, 128, v24
    v_cvt_pk_bf16_f32 v226, v0, v1
    v_exp_f32 v3, v103
    v_add_f32 v20, v20, v2
    s_waitcnt lgkmcnt(6)
    v_mfma_f32_32x32x16_bf16 v[208:223], v[44:47], v[244:247], v[208:223]
    ds_read_b64_tr_b16 v[44:45], v4 offset:8192
    ds_read_b64_tr_b16 v[46:47], v5 offset:10240
    v_xor_b32 v29, 160, v24
    v_exp_f32 v0, v104
    v_add_f32 v21, v21, v3
    s_waitcnt lgkmcnt(6)
    v_mfma_f32_32x32x16_bf16 v[160:175], v[32:35], v[248:251], v[160:175]
    ds_read_b64_tr_b16 v[32:33], v8 offset:12288
    ds_read_b64_tr_b16 v[34:35], v9 offset:14336
    v_cvt_pk_bf16_f32 v227, v2, v3
    v_exp_f32 v1, v105
    v_add_f32 v20, v20, v0
    s_waitcnt lgkmcnt(6)
    v_mfma_f32_32x32x16_bf16 v[176:191], v[36:39], v[248:251], v[176:191]
    ds_read_b64_tr_b16 v[36:37], v10 offset:12288
    ds_read_b64_tr_b16 v[38:39], v11 offset:14336
    v_xor_b32 v30, 192, v24
    v_exp_f32 v2, v106
    v_add_f32 v21, v21, v1
    s_waitcnt lgkmcnt(6)
    v_mfma_f32_32x32x16_bf16 v[192:207], v[40:43], v[248:251], v[192:207]
    ds_read_b64_tr_b16 v[40:41], v14 offset:12288
    ds_read_b64_tr_b16 v[42:43], v15 offset:14336
    v_xor_b32 v31, 224, v24
    v_cvt_pk_bf16_f32 v228, v0, v1
    v_exp_f32 v3, v107
    v_add_f32 v20, v20, v2
    s_waitcnt lgkmcnt(6)
    v_mfma_f32_32x32x16_bf16 v[208:223], v[44:47], v[248:251], v[208:223]
    ds_read_b64_tr_b16 v[44:45], v4 offset:12288
    ds_read_b64_tr_b16 v[46:47], v5 offset:14336
    v_exp_f32 v0, v108
    v_add_f32 v21, v21, v3
    s_waitcnt lgkmcnt(6)
    v_mfma_f32_32x32x16_bf16 v[160:175], v[32:35], v[252:255], v[160:175]
    s_waitcnt lgkmcnt(0)
    s_waitcnt vmcnt(10)
    s_barrier
    v_mbcnt_lo_u32_b32 v13, -1, 0
    v_mbcnt_hi_u32_b32 v13, -1, v13
    v_lshrrev_b32 v12, 3, v13
    v_mul_u32_u24 v12, 1152, v12
    v_and_b32 v6, 7, v13
    v_bfe_u32 v13, v13, 4, 1
    v_lshlrev_b32 v13, 2, v13
    v_xor_b32 v6, v6, v13
    v_lshl_add_u32 v6, v6, 4, v12
    s_lshl_b32 s49, s5, 11
    s_load_dwordx2 s[60:61], s[0:1], 32
    s_load_dwordx2 s[62:63], s[0:1], 72
    s_lshl_b32 s3, s4, 4
    s_add_u32 s3, s3, s27
    s_mul_i32 s3, s3, 288
    s_lshl_b32 s52, s5, 6
    s_min_u32 s52, s52, 224
    s_add_u32 s3, s3, s52
    s_lshl_b32 s3, s3, 7
    v_mbcnt_lo_u32_b32 v7, -1, 0
    v_mbcnt_hi_u32_b32 v7, -1, v7
    v_lshlrev_b32 v7, 7, v7
    s_waitcnt lgkmcnt(0)
    s_cmp_eq_u32 s26, 0
    s_cselect_b32 s60, s60, s62
    s_cselect_b32 s61, s61, s63
    s_and_b32 s61, s61, 0xffff
    s_mov_b32 s62, 4718592
    s_mov_b32 s63, 0x00020000
    buffer_load_dword v7, v7, s[60:63], s3 offen
    ds_read_b128 v[32:35], v24 offset:0
    v_cvt_pk_bf16_f32 v229, v2, v3
    v_exp_f32 v1, v109
    v_add_f32 v20, v20, v0
    v_mfma_f32_32x32x16_bf16 v[176:191], v[36:39], v[252:255], v[176:191]
    ds_read_b128 v[36:39], v25 offset:0
    v_exp_f32 v2, v110
    v_add_f32 v21, v21, v1
    v_mfma_f32_32x32x16_bf16 v[192:207], v[40:43], v[252:255], v[192:207]
    ds_read_b128 v[40:43], v26 offset:0
    v_cvt_pk_bf16_f32 v230, v0, v1
    v_exp_f32 v3, v111
    v_add_f32 v20, v20, v2
    v_mfma_f32_32x32x16_bf16 v[208:223], v[44:47], v[252:255], v[208:223]
    ds_read_b128 v[44:47], v27 offset:0
    v_add_f32 v21, v21, v3
    v_cvt_pk_bf16_f32 v231, v2, v3
    s_waitcnt lgkmcnt(3)
    v_mfma_f32_32x32x16_bf16 v[128:143], v[32:35], v[64:67], v[48:63]
    ds_read_b128 v[32:35], v28 offset:0
    v_add_u32 v8, 131072, v17
    v_exp_f32 v0, v112
    v_exp_f32 v1, v113
    v_add_f32 v20, v20, v0
    s_waitcnt lgkmcnt(3)
    v_mfma_f32_32x32x16_bf16 v[128:143], v[36:39], v[68:71], v[128:143]
    ds_read_b128 v[36:39], v29 offset:0
    v_xor_b32 v9, 32, v8
    v_exp_f32 v2, v114
    v_add_f32 v21, v21, v1
    s_waitcnt lgkmcnt(3)
    v_mfma_f32_32x32x16_bf16 v[128:143], v[40:43], v[72:75], v[128:143]
    ds_read_b128 v[40:43], v30 offset:0
    v_cvt_pk_bf16_f32 v232, v0, v1
    v_exp_f32 v3, v115
    v_add_f32 v20, v20, v2
    s_waitcnt lgkmcnt(3)
    v_mfma_f32_32x32x16_bf16 v[128:143], v[44:47], v[76:79], v[128:143]
    ds_read_b128 v[44:47], v31 offset:0
    v_xor_b32 v10, 64, v8
    v_exp_f32 v0, v116
    v_add_f32 v21, v21, v3
    s_waitcnt lgkmcnt(3)
    v_mfma_f32_32x32x16_bf16 v[128:143], v[32:35], v[80:83], v[128:143]
    ds_read_b128 v[32:35], v24 offset:8192
    v_xor_b32 v11, 96, v8
    v_cvt_pk_bf16_f32 v233, v2, v3
    v_exp_f32 v1, v117
    v_add_f32 v20, v20, v0
    s_waitcnt lgkmcnt(3)
    v_mfma_f32_32x32x16_bf16 v[128:143], v[36:39], v[84:87], v[128:143]
    ds_read_b128 v[36:39], v25 offset:8192
    v_exp_f32 v2, v118
    v_add_f32 v21, v21, v1
    s_waitcnt lgkmcnt(3)
    v_mfma_f32_32x32x16_bf16 v[128:143], v[40:43], v[88:91], v[128:143]
    ds_read_b128 v[40:43], v26 offset:8192
    v_xor_b32 v14, 128, v8
    v_cvt_pk_bf16_f32 v234, v0, v1
    v_exp_f32 v3, v119
    v_add_f32 v20, v20, v2
    s_waitcnt lgkmcnt(3)
    v_mfma_f32_32x32x16_bf16 v[128:143], v[44:47], v[92:95], v[128:143]
    ds_read_b128 v[44:47], v27 offset:8192
    v_xor_b32 v15, 160, v8
    v_exp_f32 v0, v120
    v_add_f32 v21, v21, v3
    s_waitcnt lgkmcnt(3)
    v_mfma_f32_32x32x16_bf16 v[144:159], v[32:35], v[64:67], v[48:63]
    ds_read_b128 v[32:35], v28 offset:8192
    v_cvt_pk_bf16_f32 v235, v2, v3
    v_exp_f32 v1, v121
    v_add_f32 v20, v20, v0
    s_waitcnt lgkmcnt(3)
    v_mfma_f32_32x32x16_bf16 v[144:159], v[36:39], v[68:71], v[144:159]
    ds_read_b128 v[36:39], v29 offset:8192
    v_xor_b32 v4, 192, v8
    v_exp_f32 v2, v122
    v_add_f32 v21, v21, v1
    s_waitcnt lgkmcnt(3)
    v_mfma_f32_32x32x16_bf16 v[144:159], v[40:43], v[72:75], v[144:159]
    ds_read_b128 v[40:43], v30 offset:8192
    v_xor_b32 v5, 224, v8
    v_cvt_pk_bf16_f32 v236, v0, v1
    v_exp_f32 v3, v123
    v_add_f32 v20, v20, v2
    s_waitcnt lgkmcnt(3)
    v_mfma_f32_32x32x16_bf16 v[144:159], v[44:47], v[76:79], v[144:159]
    ds_read_b128 v[44:47], v31 offset:8192
    v_exp_f32 v0, v124
    v_add_f32 v21, v21, v3
    s_waitcnt lgkmcnt(3)
    v_mfma_f32_32x32x16_bf16 v[144:159], v[32:35], v[80:83], v[144:159]
    ds_read_b64_tr_b16 v[32:33], v8 offset:0
    ds_read_b64_tr_b16 v[34:35], v9 offset:2048
    v_cvt_pk_bf16_f32 v237, v2, v3
    v_exp_f32 v1, v125
    v_add_f32 v20, v20, v0
    s_waitcnt lgkmcnt(4)
    v_mfma_f32_32x32x16_bf16 v[144:159], v[36:39], v[84:87], v[144:159]
    ds_read_b64_tr_b16 v[36:37], v10 offset:0
    ds_read_b64_tr_b16 v[38:39], v11 offset:2048
    v_exp_f32 v2, v126
    v_add_f32 v21, v21, v1
    s_waitcnt lgkmcnt(5)
    v_mfma_f32_32x32x16_bf16 v[144:159], v[40:43], v[88:91], v[144:159]
    ds_read_b64_tr_b16 v[40:41], v14 offset:0
    ds_read_b64_tr_b16 v[42:43], v15 offset:2048
    v_cvt_pk_bf16_f32 v238, v0, v1
    v_exp_f32 v3, v127
    v_add_f32 v20, v20, v2
    s_waitcnt lgkmcnt(6)
    v_mfma_f32_32x32x16_bf16 v[144:159], v[44:47], v[92:95], v[144:159]
    ds_read_b64_tr_b16 v[44:45], v4 offset:0
    ds_read_b64_tr_b16 v[46:47], v5 offset:2048
    v_add_f32 v21, v21, v3
    v_cvt_pk_bf16_f32 v239, v2, v3
    v_add_f32 v20, v20, v21
    v_cmp_nge_f32 vcc, s56, v20
    s_nop 1
    s_cbranch_vccnz K1_SLOW4
K1_BACK4:
    v_add_f32 v18, v18, v20
    s_waitcnt lgkmcnt(6)
    v_mfma_f32_32x32x16_bf16 v[160:175], v[32:35], v[224:227], v[160:175]
    ds_read_b64_tr_b16 v[32:33], v8 offset:4096
    ds_read_b64_tr_b16 v[34:35], v9 offset:6144
    v_add_u32 v24, 147456, v16
    v_exp_f32 v0, v128
    v_exp_f32 v1, v129
    v_mov_b32 v20, v0
    s_waitcnt lgkmcnt(6)
    v_mfma_f32_32x32x16_bf16 v[176:191], v[36:39], v[224:227], v[176:191]
    ds_read_b64_tr_b16 v[36:37], v10 offset:4096
    ds_read_b64_tr_b16 v[38:39], v11 offset:6144
    v_xor_b32 v25, 32, v24
    v_exp_f32 v2, v130
    v_mov_b32 v21, v1
    s_waitcnt lgkmcnt(6)
    v_mfma_f32_32x32x16_bf16 v[192:207], v[40:43], v[224:227], v[192:207]
    ds_read_b64_tr_b16 v[40:41], v14 offset:4096
    ds_read_b64_tr_b16 v[42:43], v15 offset:6144
    v_cvt_pk_bf16_f32 v240, v0, v1
    v_exp_f32 v3, v131
    v_add_f32 v20, v20, v2
    s_waitcnt lgkmcnt(6)
    v_mfma_f32_32x32x16_bf16 v[208:223], v[44:47], v[224:227], v[208:223]
    ds_read_b64_tr_b16 v[44:45], v4 offset:4096
    ds_read_b64_tr_b16 v[46:47], v5 offset:6144
    v_xor_b32 v26, 64, v24
    v_exp_f32 v0, v132
    v_add_f32 v21, v21, v3
    s_waitcnt lgkmcnt(6)
    v_mfma_f32_32x32x16_bf16 v[160:175], v[32:35], v[228:231], v[160:175]
    ds_read_b64_tr_b16 v[32:33], v8 offset:8192
    ds_read_b64_tr_b16 v[34:35], v9 offset:10240
    v_xor_b32 v27, 96, v24
    v_cvt_pk_bf16_f32 v241, v2, v3
    v_exp_f32 v1, v133
    v_add_f32 v20, v20, v0
    s_waitcnt lgkmcnt(6)
    v_mfma_f32_32x32x16_bf16 v[176:191], v[36:39], v[228:231], v[176:191]
    ds_read_b64_tr_b16 v[36:37], v10 offset:8192
    ds_read_b64_tr_b16 v[38:39], v11 offset:10240
    v_exp_f32 v2, v134
    v_add_f32 v21, v21, v1
    s_waitcnt lgkmcnt(6)
    v_mfma_f32_32x32x16_bf16 v[192:207], v[40:43], v[228:231], v[192:207]
    ds_read_b64_tr_b16 v[40:41], v14 offset:8192
    ds_read_b64_tr_b16 v[42:43], v15 offset:10240
    v_xor_b32 v28, 128, v24
    v_cvt_pk_bf16_f32 v242, v0, v1
    v_exp_f32 v3, v135
    v_add_f32 v20, v20, v2
    s_waitcnt lgkmcnt(6)
    v_mfma_f32_32x32x16_bf16 v[208:223], v[44:47], v[228:231], v[208:223]
    ds_read_b64_tr_b16 v[44:45], v4 offset:8192
    ds_read_b64_tr_b16 v[46:47], v5 offset:10240
    v_xor_b32 v29, 160, v24
    v_exp_f32 v0, v136
    v_add_f32 v21, v21, v3
    s_waitcnt lgkmcnt(6)
    v_mfma_f32_32x32x16_bf16 v[160:175], v[32:35], v[232:235], v[160:175]
    ds_read_b64_tr_b16 v[32:33], v8 offset:12288
    ds_read_b64_tr_b16 v[34:35], v9 offset:14336
    v_cvt_pk_bf16_f32 v243, v2, v3
    v_exp_f32 v1, v137
    v_add_f32 v20, v20, v0
    s_waitcnt lgkmcnt(6)
    v_mfma_f32_32x32x16_bf16 v[176:191], v[36:39], v[232:235], v[176:191]
    ds_read_b64_tr_b16 v[36:37], v10 offset:12288
    ds_read_b64_tr_b16 v[38:39], v11 offset:14336
    v_xor_b32 v30, 192, v24
    v_exp_f32 v2, v138
    v_add_f32 v21, v21, v1
    s_waitcnt lgkmcnt(6)
    v_mfma_f32_32x32x16_bf16 v[192:207], v[40:43], v[232:235], v[192:207]
    ds_read_b64_tr_b16 v[40:41], v14 offset:12288
    ds_read_b64_tr_b16 v[42:43], v15 offset:14336
    v_xor_b32 v31, 224, v24
    v_cvt_pk_bf16_f32 v244, v0, v1
    v_exp_f32 v3, v139
    v_add_f32 v20, v20, v2
    s_waitcnt lgkmcnt(6)
    v_mfma_f32_32x32x16_bf16 v[208:223], v[44:47], v[232:235], v[208:223]
    ds_read_b64_tr_b16 v[44:45], v4 offset:12288
    ds_read_b64_tr_b16 v[46:47], v5 offset:14336
    v_exp_f32 v0, v140
    v_add_f32 v21, v21, v3
    s_waitcnt lgkmcnt(6)
    v_mfma_f32_32x32x16_bf16 v[160:175], v[32:35], v[236:239], v[160:175]
    s_waitcnt lgkmcnt(0)
    s_waitcnt vmcnt(7)
    s_barrier
    ds_read_b128 v[32:35], v24 offset:0
    v_cvt_pk_bf16_f32 v245, v2, v3
    v_exp_f32 v1, v141
    v_add_f32 v20, v20, v0
    s_add_u32 s52, s50, 0
    s_add_u32 m0, s49, 98304
    s_nop 0
    buffer_load_dwordx4 v6, s[28:31], s52 offen lds
    v_mfma_f32_32x32x16_bf16 v[176:191], v[36:39], v[236:239], v[176:191]
    ds_read_b128 v[36:39], v25 offset:0
    v_exp_f32 v2, v142
    v_add_f32 v21, v21, v1
    s_add_u32 s52, s50, 9216
    s_add_u32 m0, s49, 99328
    s_nop 0
    buffer_load_dwordx4 v6, s[28:31], s52 offen lds
    v_mfma_f32_32x32x16_bf16 v[192:207], v[40:43], v[236:239], v[192:207]
    ds_read_b128 v[40:43], v26 offset:0
    v_cvt_pk_bf16_f32 v246, v0, v1
    v_exp_f32 v3, v143
    v_add_f32 v20, v20, v2
    s_add_u32 s52, s50, 18432
    s_add_u32 m0, s49, 114688
    s_nop 0
    buffer_load_dwordx4 v6, s[28:31], s52 offen lds
    v_mfma_f32_32x32x16_bf16 v[208:223], v[44:47], v[236:239], v[208:223]
    ds_read_b128 v[44:47], v27 offset:0
    v_add_f32 v21, v21, v3
    v_cvt_pk_bf16_f32 v247, v2, v3
    s_add_u32 s52, s50, 27648
    s_add_u32 m0, s49, 115712
    s_nop 0
    buffer_load_dwordx4 v6, s[28:31], s52 offen lds
    s_waitcnt lgkmcnt(3)
    v_mfma_f32_32x32x16_bf16 v[96:111], v[32:35], v[64:67], v[48:63]
    ds_read_b128 v[32:35], v28 offset:0
    v_add_u32 v8, 0, v17
    v_exp_f32 v0, v144
    v_exp_f32 v1, v145
    v_add_f32 v20, v20, v0
    s_add_u32 s52, s50, 36864
    s_add_u32 m0, s49, 32768
    s_nop 0
    buffer_load_dwordx4 v6, s[28:31], s52 offen lds
    s_waitcnt lgkmcnt(3)
    v_mfma_f32_32x32x16_bf16 v[96:111], v[36:39], v[68:71], v[96:111]
    ds_read_b128 v[36:39], v29 offset:0
    v_xor_b32 v9, 32, v8
    v_exp_f32 v2, v146
    v_add_f32 v21, v21, v1
    s_add_u32 s52, s50, 46080
    s_add_u32 m0, s49, 33792
    s_nop 0
    buffer_load_dwordx4 v6, s[28:31], s52 offen lds
    s_waitcnt lgkmcnt(3)
    v_mfma_f32_32x32x16_bf16 v[96:111], v[40:43], v[72:75], v[96:111]
    ds_read_b128 v[40:43], v30 offset:0
    v_cvt_pk_bf16_f32 v248, v0, v1
    v_exp_f32 v3, v147
    v_add_f32 v20, v20, v2
    s_add_u32 s52, s50, 55296
    s_add_u32 m0, s49, 49152
    s_nop 0
    buffer_load_dwordx4 v6, s[28:31], s52 offen lds
    s_waitcnt lgkmcnt(3)
    v_mfma_f32_32x32x16_bf16 v[96:111], v[44:47], v[76:79], v[96:111]
    ds_read_b128 v[44:47], v31 offset:0
    v_xor_b32 v10, 64, v8
    v_exp_f32 v0, v148
    v_add_f32 v21, v21, v3
    s_add_u32 s52, s50, 64512
    s_add_u32 m0, s49, 50176
    s_nop 0
    buffer_load_dwordx4 v6, s[28:31], s52 offen lds
    s_waitcnt lgkmcnt(3)
    v_mfma_f32_32x32x16_bf16 v[96:111], v[32:35], v[80:83], v[96:111]
    ds_read_b128 v[32:35], v24 offset:8192
    v_xor_b32 v11, 96, v8
    v_cvt_pk_bf16_f32 v249, v2, v3
    v_exp_f32 v1, v149
    v_add_f32 v20, v20, v0
    s_add_u32 s52, s50, 73728
    s_add_u32 m0, s49, 131072
    s_nop 0
    buffer_load_dwordx4 v6, s[28:31], s52 offen lds
    s_waitcnt lgkmcnt(3)
    v_mfma_f32_32x32x16_bf16 v[96:111], v[36:39], v[84:87], v[96:111]
    ds_read_b128 v[36:39], v25 offset:8192
    v_exp_f32 v2, v150
    v_add_f32 v21, v21, v1
    s_add_u32 s52, s50, 82944
    s_add_u32 m0, s49, 132096
    s_nop 0
    buffer_load_dwordx4 v6, s[28:31], s52 offen lds
    s_waitcnt lgkmcnt(3)
    v_mfma_f32_32x32x16_bf16 v[96:111], v[40:43], v[88:91], v[96:111]
    ds_read_b128 v[40:43], v26 offset:8192
    v_xor_b32 v14, 128, v8
    v_cvt_pk_bf16_f32 v250, v0, v1
    v_exp_f32 v3, v151
    v_add_f32 v20, v20, v2
    s_waitcnt lgkmcnt(3)
    v_mfma_f32_32x32x16_bf16 v[96:111], v[44:47], v[92:95], v[96:111]
    ds_read_b128 v[44:47], v27 offset:8192
    v_xor_b32 v15, 160, v8
    v_exp_f32 v0, v152
    v_add_f32 v21, v21, v3
    s_waitcnt lgkmcnt(3)
    v_mfma_f32_32x32x16_bf16 v[112:127], v[32:35], v[64:67], v[48:63]
    ds_read_b128 v[32:35], v28 offset:8192
    v_cvt_pk_bf16_f32 v251, v2, v3
    v_exp_f32 v1, v153
    v_add_f32 v20, v20, v0
    s_waitcnt lgkmcnt(3)
    v_mfma_f32_32x32x16_bf16 v[112:127], v[36:39], v[68:71], v[112:127]
    ds_read_b128 v[36:39], v29 offset:8192
    v_xor_b32 v4, 192, v8
    v_exp_f32 v2, v154
    v_add_f32 v21, v21, v1
    s_waitcnt lgkmcnt(3)
    v_mfma_f32_32x32x16_bf16 v[112:127], v[40:43], v[72:75], v[112:127]
    ds_read_b128 v[40:43], v30 offset:8192
    v_xor_b32 v5, 224, v8
    v_cvt_pk_bf16_f32 v252, v0, v1
    v_exp_f32 v3, v155
    v_add_f32 v20, v20, v2
    s_waitcnt lgkmcnt(3)
    v_mfma_f32_32x32x16_bf16 v[112:127], v[44:47], v[76:79], v[112:127]
    ds_read_b128 v[44:47], v31 offset:8192
    v_exp_f32 v0, v156
    v_add_f32 v21, v21, v3
    s_waitcnt lgkmcnt(3)
    v_mfma_f32_32x32x16_bf16 v[112:127], v[32:35], v[80:83], v[112:127]
    ds_read_b64_tr_b16 v[32:33], v8 offset:0
    ds_read_b64_tr_b16 v[34:35], v9 offset:2048
    v_cvt_pk_bf16_f32 v253, v2, v3
    v_exp_f32 v1, v157
    v_add_f32 v20, v20, v0
    s_waitcnt lgkmcnt(4)
    v_mfma_f32_32x32x16_bf16 v[112:127], v[36:39], v[84:87], v[112:127]
    ds_read_b64_tr_b16 v[36:37], v10 offset:0
    ds_read_b64_tr_b16 v[38:39], v11 offset:2048
    v_exp_f32 v2, v158
    v_add_f32 v21, v21, v1
    s_waitcnt lgkmcnt(5)
    v_mfma_f32_32x32x16_bf16 v[112:127], v[40:43], v[88:91], v[112:127]
    ds_read_b64_tr_b16 v[40:41], v14 offset:0
    ds_read_b64_tr_b16 v[42:43], v15 offset:2048
    v_cvt_pk_bf16_f32 v254, v0, v1
    v_exp_f32 v3, v159
    v_add_f32 v20, v20, v2
    s_waitcnt lgkmcnt(6)
    v_mfma_f32_32x32x16_bf16 v[112:127], v[44:47], v[92:95], v[112:127]
    ds_read_b64_tr_b16 v[44:45], v4 offset:0
    ds_read_b64_tr_b16 v[46:47], v5 offset:2048
    v_add_f32 v21, v21, v3
    v_cvt_pk_bf16_f32 v255, v2, v3
    v_add_f32 v20, v20, v21
    v_cmp_nge_f32 vcc, s56, v20
    s_nop 1
    s_cbranch_vccnz K1_SLOW5
K1_BACK5:
    v_add_f32 v18, v18, v20
    s_waitcnt lgkmcnt(6)
    v_mfma_f32_32x32x16_bf16 v[160:175], v[32:35], v[240:243], v[160:175]
    ds_read_b64_tr_b16 v[32:33], v8 offset:4096
    ds_read_b64_tr_b16 v[34:35], v9 offset:6144
    v_add_u32 v24, 16384, v16
    v_exp_f32 v0, v96
    v_exp_f32 v1, v97
    v_mov_b32 v20, v0
    s_waitcnt lgkmcnt(6)
    v_mfma_f32_32x32x16_bf16 v[176:191], v[36:39], v[240:243], v[176:191]
    ds_read_b64_tr_b16 v[36:37], v10 offset:4096
    ds_read_b64_tr_b16 v[38:39], v11 offset:6144
    v_xor_b32 v25, 32, v24
    v_exp_f32 v2, v98
    v_mov_b32 v21, v1
    s_waitcnt lgkmcnt(6)
    v_mfma_f32_32x32x16_bf16 v[192:207], v[40:43], v[240:243], v[192:207]
    ds_read_b64_tr_b16 v[40:41], v14 offset:4096
    ds_read_b64_tr_b16 v[42:43], v15 offset:6144
    v_cvt_pk_bf16_f32 v224, v0, v1
    v_exp_f32 v3, v99
    v_add_f32 v20, v20, v2
    s_waitcnt lgkmcnt(6)
    v_mfma_f32_32x32x16_bf16 v[208:223], v[44:47], v[240:243], v[208:223]
    ds_read_b64_tr_b16 v[44:45], v4 offset:4096
    ds_read_b64_tr_b16 v[46:47], v5 offset:6144
    v_xor_b32 v26, 64, v24
    v_exp_f32 v0, v100
    v_add_f32 v21, v21, v3
    s_waitcnt lgkmcnt(6)
    v_mfma_f32_32x32x16_bf16 v[160:175], v[32:35], v[244:247], v[160:175]
    ds_read_b64_tr_b16 v[32:33], v8 offset:8192
    ds_read_b64_tr_b16 v[34:35], v9 offset:10240
    v_xor_b32 v27, 96, v24
    v_cvt_pk_bf16_f32 v225, v2, v3
    v_exp_f32 v1, v101
    v_add_f32 v20, v20, v0
    s_waitcnt lgkmcnt(6)
    v_mfma_f32_32x32x16_bf16 v[176:191], v[36:39], v[244:247], v[176:191]
    ds_read_b64_tr_b16 v[36:37], v10 offset:8192
    ds_read_b64_tr_b16 v[38:39], v11 offset:10240
    v_exp_f32 v2, v102
    v_add_f32 v21, v21, v1
    s_waitcnt lgkmcnt(6)
    v_mfma_f32_32x32x16_bf16 v[192:207], v[40:43], v[244:247], v[192:207]
    ds_read_b64_tr_b16 v[40:41], v14 offset:8192
    ds_read_b64_tr_b16 v[42:43], v15 offset:10240
    v_xor_b32 v28, 128, v24
    v_cvt_pk_bf16_f32 v226, v0, v1
    v_exp_f32 v3, v103
    v_add_f32 v20, v20, v2
    s_waitcnt lgkmcnt(6)
    v_mfma_f32_32x32x16_bf16 v[208:223], v[44:47], v[244:247], v[208:223]
    ds_read_b64_tr_b16 v[44:45], v4 offset:8192
    ds_read_b64_tr_b16 v[46:47], v5 offset:10240
    v_xor_b32 v29, 160, v24
    v_exp_f32 v0, v104
    v_add_f32 v21, v21, v3
    s_waitcnt lgkmcnt(6)
    v_mfma_f32_32x32x16_bf16 v[160:175], v[32:35], v[248:251], v[160:175]
    ds_read_b64_tr_b16 v[32:33], v8 offset:12288
    ds_read_b64_tr_b16 v[34:35], v9 offset:14336
    v_cvt_pk_bf16_f32 v227, v2, v3
    v_exp_f32 v1, v105
    v_add_f32 v20, v20, v0
    s_waitcnt lgkmcnt(6)
    v_mfma_f32_32x32x16_bf16 v[176:191], v[36:39], v[248:251], v[176:191]
    ds_read_b64_tr_b16 v[36:37], v10 offset:12288
    ds_read_b64_tr_b16 v[38:39], v11 offset:14336
    v_xor_b32 v30, 192, v24
    v_exp_f32 v2, v106
    v_add_f32 v21, v21, v1
    s_waitcnt lgkmcnt(6)
    v_mfma_f32_32x32x16_bf16 v[192:207], v[40:43], v[248:251], v[192:207]
    ds_read_b64_tr_b16 v[40:41], v14 offset:12288
    ds_read_b64_tr_b16 v[42:43], v15 offset:14336
    v_xor_b32 v31, 224, v24
    v_cvt_pk_bf16_f32 v228, v0, v1
    v_exp_f32 v3, v107
    v_add_f32 v20, v20, v2
    s_waitcnt lgkmcnt(6)
    v_mfma_f32_32x32x16_bf16 v[208:223], v[44:47], v[248:251], v[208:223]
    ds_read_b64_tr_b16 v[44:45], v4 offset:12288
    ds_read_b64_tr_b16 v[46:47], v5 offset:14336
    v_exp_f32 v0, v108
    v_add_f32 v21, v21, v3
    s_waitcnt lgkmcnt(6)
    v_mfma_f32_32x32x16_bf16 v[160:175], v[32:35], v[252:255], v[160:175]
    s_waitcnt lgkmcnt(0)
    s_waitcnt vmcnt(13)
    s_barrier
    ds_read_b128 v[32:35], v24 offset:0
    v_cvt_pk_bf16_f32 v229, v2, v3
    v_exp_f32 v1, v109
    v_add_f32 v20, v20, v0
    s_add_u32 s52, s50, 92160
    s_add_u32 m0, s49, 147456
    s_nop 0
    buffer_load_dwordx4 v6, s[28:31], s52 offen lds
    v_mfma_f32_32x32x16_bf16 v[176:191], v[36:39], v[252:255], v[176:191]
    ds_read_b128 v[36:39], v25 offset:0
    v_exp_f32 v2, v110
    v_add_f32 v21, v21, v1
    s_add_u32 s52, s50, 101376
    s_add_u32 m0, s49, 148480
    s_nop 0
    buffer_load_dwordx4 v6, s[28:31], s52 offen lds
    v_mfma_f32_32x32x16_bf16 v[192:207], v[40:43], v[252:255], v[192:207]
    ds_read_b128 v[40:43], v26 offset:0
    v_cvt_pk_bf16_f32 v230, v0, v1
    v_exp_f32 v3, v111
    v_add_f32 v20, v20, v2
    s_add_u32 s52, s50, 110592
    s_add_u32 m0, s49, 0
    s_nop 0
    buffer_load_dwordx4 v6, s[28:31], s52 offen lds
    v_mfma_f32_32x32x16_bf16 v[208:223], v[44:47], v[252:255], v[208:223]
    ds_read_b128 v[44:47], v27 offset:0
    v_add_f32 v21, v21, v3
    v_cvt_pk_bf16_f32 v231, v2, v3
    s_add_u32 s52, s50, 119808
    s_add_u32 m0, s49, 1024
    s_nop 0
    buffer_load_dwordx4 v6, s[28:31], s52 offen lds
    s_waitcnt lgkmcnt(3)
    v_mfma_f32_32x32x16_bf16 v[128:143], v[32:35], v[64:67], v[48:63]
    ds_read_b128 v[32:35], v28 offset:0
    v_add_u32 v8, 65536, v17
    v_exp_f32 v0, v112
    v_exp_f32 v1, v113
    v_add_f32 v20, v20, v0
    s_waitcnt lgkmcnt(3)
    v_mfma_f32_32x32x16_bf16 v[128:143], v[36:39], v[68:71], v[128:143]
    ds_read_b128 v[36:39], v29 offset:0
    v_xor_b32 v9, 32, v8
    v_exp_f32 v2, v114
    v_add_f32 v21, v21, v1
    s_waitcnt lgkmcnt(3)
    v_mfma_f32_32x32x16_bf16 v[128:143], v[40:43], v[72:75], v[128:143]
    ds_read_b128 v[40:43], v30 offset:0
    v_cvt_pk_bf16_f32 v232, v0, v1
    v_exp_f32 v3, v115
    v_add_f32 v20, v20, v2
    s_waitcnt lgkmcnt(3)
    v_mfma_f32_32x32x16_bf16 v[128:143], v[44:47], v[76:79], v[128:143]
    ds_read_b128 v[44:47], v31 offset:0
    v_xor_b32 v10, 64, v8
    v_exp_f32 v0, v116
    v_add_f32 v21, v21, v3
    s_waitcnt lgkmcnt(3)
    v_mfma_f32_32x32x16_bf16 v[128:143], v[32:35], v[80:83], v[128:143]
    ds_read_b128 v[32:35], v24 offset:8192
    v_xor_b32 v11, 96, v8
    v_cvt_pk_bf16_f32 v233, v2, v3
    v_exp_f32 v1, v117
    v_add_f32 v20, v20, v0
    s_waitcnt lgkmcnt(3)
    v_mfma_f32_32x32x16_bf16 v[128:143], v[36:39], v[84:87], v[128:143]
    ds_read_b128 v[36:39], v25 offset:8192
    v_exp_f32 v2, v118
    v_add_f32 v21, v21, v1
    s_waitcnt lgkmcnt(3)
    v_mfma_f32_32x32x16_bf16 v[128:143], v[40:43], v[88:91], v[128:143]
    ds_read_b128 v[40:43], v26 offset:8192
    v_xor_b32 v14, 128, v8
    v_cvt_pk_bf16_f32 v234, v0, v1
    v_exp_f32 v3, v119
    v_add_f32 v20, v20, v2
    s_waitcnt lgkmcnt(3)
    v_mfma_f32_32x32x16_bf16 v[128:143], v[44:47], v[92:95], v[128:143]
    ds_read_b128 v[44:47], v27 offset:8192
    v_xor_b32 v15, 160, v8
    v_exp_f32 v0, v120
    v_add_f32 v21, v21, v3
    s_waitcnt lgkmcnt(3)
    v_mfma_f32_32x32x16_bf16 v[144:159], v[32:35], v[64:67], v[48:63]
    ds_read_b128 v[32:35], v28 offset:8192
    v_cvt_pk_bf16_f32 v235, v2, v3
    v_exp_f32 v1, v121
    v_add_f32 v20, v20, v0
    s_waitcnt lgkmcnt(3)
    v_mfma_f32_32x32x16_bf16 v[144:159], v[36:39], v[68:71], v[144:159]
    ds_read_b128 v[36:39], v29 offset:8192
    v_xor_b32 v4, 192, v8
    v_exp_f32 v2, v122
    v_add_f32 v21, v21, v1
    s_waitcnt lgkmcnt(3)
    v_mfma_f32_32x32x16_bf16 v[144:159], v[40:43], v[72:75], v[144:159]
    ds_read_b128 v[40:43], v30 offset:8192
    v_xor_b32 v5, 224, v8
    v_cvt_pk_bf16_f32 v236, v0, v1
    v_exp_f32 v3, v123
    v_add_f32 v20, v20, v2
    s_waitcnt lgkmcnt(3)
    v_mfma_f32_32x32x16_bf16 v[144:159], v[44:47], v[76:79], v[144:159]
    ds_read_b128 v[44:47], v31 offset:8192
    v_exp_f32 v0, v124
    v_add_f32 v21, v21, v3
    s_waitcnt lgkmcnt(3)
    v_mfma_f32_32x32x16_bf16 v[144:159], v[32:35], v[80:83], v[144:159]
    ds_read_b64_tr_b16 v[32:33], v8 offset:0
    ds_read_b64_tr_b16 v[34:35], v9 offset:2048
    v_cvt_pk_bf16_f32 v237, v2, v3
    v_exp_f32 v1, v125
    v_add_f32 v20, v20, v0
    s_waitcnt lgkmcnt(4)
    v_mfma_f32_32x32x16_bf16 v[144:159], v[36:39], v[84:87], v[144:159]
    ds_read_b64_tr_b16 v[36:37], v10 offset:0
    ds_read_b64_tr_b16 v[38:39], v11 offset:2048
    v_exp_f32 v2, v126
    v_add_f32 v21, v21, v1
    s_waitcnt lgkmcnt(5)
    v_mfma_f32_32x32x16_bf16 v[144:159], v[40:43], v[88:91], v[144:159]
    ds_read_b64_tr_b16 v[40:41], v14 offset:0
    ds_read_b64_tr_b16 v[42:43], v15 offset:2048
    v_cvt_pk_bf16_f32 v238, v0, v1
    v_exp_f32 v3, v127
    v_add_f32 v20, v20, v2
    s_waitcnt lgkmcnt(6)
    v_mfma_f32_32x32x16_bf16 v[144:159], v[44:47], v[92:95], v[144:159]
    ds_read_b64_tr_b16 v[44:45], v4 offset:0
    ds_read_b64_tr_b16 v[46:47], v5 offset:2048
    v_add_f32 v21, v21, v3
    v_cvt_pk_bf16_f32 v239, v2, v3
    v_add_f32 v20, v20, v21
    v_cmp_nge_f32 vcc, s56, v20
    s_nop 1
    s_cbranch_vccnz K1_SLOW6
K1_BACK6:
    v_add_f32 v18, v18, v20
    s_waitcnt lgkmcnt(6)
    v_mfma_f32_32x32x16_bf16 v[160:175], v[32:35], v[224:227], v[160:175]
    ds_read_b64_tr_b16 v[32:33], v8 offset:4096
    ds_read_b64_tr_b16 v[34:35], v9 offset:6144
    v_add_u32 v24, 81920, v17
    v_exp_f32 v0, v128
    v_exp_f32 v1, v129
    v_mov_b32 v20, v0
    v_exp_f32 v2, v130
    v_mov_b32 v21, v1
    s_waitcnt lgkmcnt(6)
    v_mfma_f32_32x32x16_bf16 v[176:191], v[36:39], v[224:227], v[176:191]
    ds_read_b64_tr_b16 v[36:37], v10 offset:4096
    ds_read_b64_tr_b16 v[38:39], v11 offset:6144
    v_xor_b32 v25, 32, v24
    v_cvt_pk_bf16_f32 v240, v0, v1
    v_exp_f32 v3, v131
    v_add_f32 v20, v20, v2
    v_exp_f32 v0, v132
    v_add_f32 v21, v21, v3
    s_waitcnt lgkmcnt(6)
    v_mfma_f32_32x32x16_bf16 v[192:207], v[40:43], v[224:227], v[192:207]
    ds_read_b64_tr_b16 v[40:41], v14 offset:4096
    ds_read_b64_tr_b16 v[42:43], v15 offset:6144
    v_cvt_pk_bf16_f32 v241, v2, v3
    v_exp_f32 v1, v133
    v_add_f32 v20, v20, v0
    v_exp_f32 v2, v134
    v_add_f32 v21, v21, v1
    s_waitcnt lgkmcnt(6)
    v_mfma_f32_32x32x16_bf16 v[208:223], v[44:47], v[224:227], v[208:223]
    ds_read_b64_tr_b16 v[44:45], v4 offset:4096
    ds_read_b64_tr_b16 v[46:47], v5 offset:6144
    v_xor_b32 v26, 64, v24
    v_cvt_pk_bf16_f32 v242, v0, v1
    v_exp_f32 v3, v135
    v_add_f32 v20, v20, v2
    v_exp_f32 v0, v136
    v_add_f32 v21, v21, v3
    s_waitcnt lgkmcnt(6)
    v_mfma_f32_32x32x16_bf16 v[160:175], v[32:35], v[228:231], v[160:175]
    ds_read_b64_tr_b16 v[32:33], v8 offset:8192
    ds_read_b64_tr_b16 v[34:35], v9 offset:10240
    v_xor_b32 v27, 96, v24
    v_cvt_pk_bf16_f32 v243, v2, v3
    v_exp_f32 v1, v137
    v_add_f32 v20, v20, v0
    v_exp_f32 v2, v138
    v_add_f32 v21, v21, v1
    s_waitcnt lgkmcnt(6)
    v_mfma_f32_32x32x16_bf16 v[176:191], v[36:39], v[228:231], v[176:191]
    ds_read_b64_tr_b16 v[36:37], v10 offset:8192
    ds_read_b64_tr_b16 v[38:39], v11 offset:10240
    v_cvt_pk_bf16_f32 v244, v0, v1
    v_exp_f32 v3, v139
    v_add_f32 v20, v20, v2
    v_exp_f32 v0, v140
    v_add_f32 v21, v21, v3
    s_waitcnt lgkmcnt(6)
    v_mfma_f32_32x32x16_bf16 v[192:207], v[40:43], v[228:231], v[192:207]
    ds_read_b64_tr_b16 v[40:41], v14 offset:8192
    ds_read_b64_tr_b16 v[42:43], v15 offset:10240
    v_xor_b32 v28, 128, v24
    v_cvt_pk_bf16_f32 v245, v2, v3
    v_exp_f32 v1, v141
    v_add_f32 v20, v20, v0
    v_exp_f32 v2, v142
    v_add_f32 v21, v21, v1
    s_waitcnt lgkmcnt(6)
    v_mfma_f32_32x32x16_bf16 v[208:223], v[44:47], v[228:231], v[208:223]
    ds_read_b64_tr_b16 v[44:45], v4 offset:8192
    ds_read_b64_tr_b16 v[46:47], v5 offset:10240
    v_xor_b32 v29, 160, v24
    v_cvt_pk_bf16_f32 v246, v0, v1
    v_exp_f32 v3, v143
    v_add_f32 v20, v20, v2
    v_exp_f32 v0, v144
    v_add_f32 v21, v21, v3
    s_waitcnt lgkmcnt(6)
    v_mfma_f32_32x32x16_bf16 v[160:175], v[32:35], v[232:235], v[160:175]
    ds_read_b64_tr_b16 v[32:33], v8 offset:12288
    ds_read_b64_tr_b16 v[34:35], v9 offset:14336
    v_cvt_pk_bf16_f32 v247, v2, v3
    v_exp_f32 v1, v145
    v_add_f32 v20, v20, v0
    v_exp_f32 v2, v146
    v_add_f32 v21, v21, v1
    s_waitcnt lgkmcnt(6)
    v_mfma_f32_32x32x16_bf16 v[176:191], v[36:39], v[232:235], v[176:191]
    ds_read_b64_tr_b16 v[36:37], v10 offset:12288
    ds_read_b64_tr_b16 v[38:39], v11 offset:14336
    v_xor_b32 v30, 192, v24
    v_cvt_pk_bf16_f32 v248, v0, v1
    v_exp_f32 v3, v147
    v_add_f32 v20, v20, v2
    v_exp_f32 v0, v148
    v_add_f32 v21, v21, v3
    s_waitcnt lgkmcnt(6)
    v_mfma_f32_32x32x16_bf16 v[192:207], v[40:43], v[232:235], v[192:207]
    ds_read_b64_tr_b16 v[40:41], v14 offset:12288
    ds_read_b64_tr_b16 v[42:43], v15 offset:14336
    v_xor_b32 v31, 224, v24
    v_cvt_pk_bf16_f32 v249, v2, v3
    v_exp_f32 v1, v149
    v_add_f32 v20, v20, v0
    v_exp_f32 v2, v150
    v_add_f32 v21, v21, v1
    s_waitcnt lgkmcnt(6)
    v_mfma_f32_32x32x16_bf16 v[208:223], v[44:47], v[232:235], v[208:223]
    ds_read_b64_tr_b16 v[44:45], v4 offset:12288
    ds_read_b64_tr_b16 v[46:47], v5 offset:14336
    v_cvt_pk_bf16_f32 v250, v0, v1
    v_exp_f32 v3, v151
    v_add_f32 v20, v20, v2
    v_exp_f32 v0, v152
    v_add_f32 v21, v21, v3
    s_waitcnt lgkmcnt(6)
    v_mfma_f32_32x32x16_bf16 v[160:175], v[32:35], v[236:239], v[160:175]
    s_waitcnt lgkmcnt(0)
    s_waitcnt vmcnt(15)
    s_barrier
    ds_read_b64_tr_b16 v[32:33], v24 offset:0
    ds_read_b64_tr_b16 v[34:35], v25 offset:2048
    v_cvt_pk_bf16_f32 v251, v2, v3
    v_exp_f32 v1, v153
    v_add_f32 v20, v20, v0
    v_exp_f32 v2, v154
    v_add_f32 v21, v21, v1
    v_mfma_f32_32x32x16_bf16 v[176:191], v[36:39], v[236:239], v[176:191]
    ds_read_b64_tr_b16 v[36:37], v26 offset:0
    ds_read_b64_tr_b16 v[38:39], v27 offset:2048
    v_cvt_pk_bf16_f32 v252, v0, v1
    v_exp_f32 v3, v155
    v_add_f32 v20, v20, v2
    v_exp_f32 v0, v156
    v_add_f32 v21, v21, v3
    v_mfma_f32_32x32x16_bf16 v[192:207], v[40:43], v[236:239], v[192:207]
    ds_read_b64_tr_b16 v[40:41], v28 offset:0
    ds_read_b64_tr_b16 v[42:43], v29 offset:2048
    v_cvt_pk_bf16_f32 v253, v2, v3
    v_exp_f32 v1, v157
    v_add_f32 v20, v20, v0
    v_exp_f32 v2, v158
    v_add_f32 v21, v21, v1
    v_mfma_f32_32x32x16_bf16 v[208:223], v[44:47], v[236:239], v[208:223]
    ds_read_b64_tr_b16 v[44:45], v30 offset:0
    ds_read_b64_tr_b16 v[46:47], v31 offset:2048
    v_cvt_pk_bf16_f32 v254, v0, v1
    v_exp_f32 v3, v159
    v_add_f32 v20, v20, v2
    v_add_f32 v21, v21, v3
    v_cvt_pk_bf16_f32 v255, v2, v3
    v_add_f32 v20, v20, v21
    v_cmp_nge_f32 vcc, s56, v20
    s_nop 1
    s_cbranch_vccnz K1_SLOW7
K1_BACK7:
    v_add_f32 v18, v18, v20
    s_waitcnt lgkmcnt(6)
    v_mfma_f32_32x32x16_bf16 v[160:175], v[32:35], v[240:243], v[160:175]
    ds_read_b64_tr_b16 v[32:33], v24 offset:4096
    ds_read_b64_tr_b16 v[34:35], v25 offset:6144
    s_waitcnt lgkmcnt(6)
    v_mfma_f32_32x32x16_bf16 v[176:191], v[36:39], v[240:243], v[176:191]
    ds_read_b64_tr_b16 v[36:37], v26 offset:4096
    ds_read_b64_tr_b16 v[38:39], v27 offset:6144
    s_waitcnt lgkmcnt(6)
    v_mfma_f32_32x32x16_bf16 v[192:207], v[40:43], v[240:243], v[192:207]
    ds_read_b64_tr_b16 v[40:41], v28 offset:4096
    ds_read_b64_tr_b16 v[42:43], v29 offset:6144
    s_waitcnt lgkmcnt(6)
    v_mfma_f32_32x32x16_bf16 v[208:223], v[44:47], v[240:243], v[208:223]
    ds_read_b64_tr_b16 v[44:45], v30 offset:4096
    ds_read_b64_tr_b16 v[46:47], v31 offset:6144
    s_waitcnt lgkmcnt(6)
    v_mfma_f32_32x32x16_bf16 v[160:175], v[32:35], v[244:247], v[160:175]
    ds_read_b64_tr_b16 v[32:33], v24 offset:8192
    ds_read_b64_tr_b16 v[34:35], v25 offset:10240
    s_waitcnt lgkmcnt(6)
    v_mfma_f32_32x32x16_bf16 v[176:191], v[36:39], v[244:247], v[176:191]
    ds_read_b64_tr_b16 v[36:37], v26 offset:8192
    ds_read_b64_tr_b16 v[38:39], v27 offset:10240
    s_waitcnt lgkmcnt(6)
    v_mfma_f32_32x32x16_bf16 v[192:207], v[40:43], v[244:247], v[192:207]
    ds_read_b64_tr_b16 v[40:41], v28 offset:8192
    ds_read_b64_tr_b16 v[42:43], v29 offset:10240
    s_waitcnt lgkmcnt(6)
    v_mfma_f32_32x32x16_bf16 v[208:223], v[44:47], v[244:247], v[208:223]
    ds_read_b64_tr_b16 v[44:45], v30 offset:8192
    ds_read_b64_tr_b16 v[46:47], v31 offset:10240
    s_waitcnt lgkmcnt(6)
    v_mfma_f32_32x32x16_bf16 v[160:175], v[32:35], v[248:251], v[160:175]
    ds_read_b64_tr_b16 v[32:33], v24 offset:12288
    ds_read_b64_tr_b16 v[34:35], v25 offset:14336
    s_waitcnt lgkmcnt(6)
    v_mfma_f32_32x32x16_bf16 v[176:191], v[36:39], v[248:251], v[176:191]
    ds_read_b64_tr_b16 v[36:37], v26 offset:12288
    ds_read_b64_tr_b16 v[38:39], v27 offset:14336
    s_waitcnt lgkmcnt(6)
    v_mfma_f32_32x32x16_bf16 v[192:207], v[40:43], v[248:251], v[192:207]
    ds_read_b64_tr_b16 v[40:41], v28 offset:12288
    ds_read_b64_tr_b16 v[42:43], v29 offset:14336
    s_waitcnt lgkmcnt(6)
    v_mfma_f32_32x32x16_bf16 v[208:223], v[44:47], v[248:251], v[208:223]
    ds_read_b64_tr_b16 v[44:45], v30 offset:12288
    ds_read_b64_tr_b16 v[46:47], v31 offset:14336
    s_waitcnt lgkmcnt(6)
    v_mfma_f32_32x32x16_bf16 v[160:175], v[32:35], v[252:255], v[160:175]
    s_waitcnt lgkmcnt(4)
    v_mfma_f32_32x32x16_bf16 v[176:191], v[36:39], v[252:255], v[176:191]
    s_waitcnt lgkmcnt(2)
    v_mfma_f32_32x32x16_bf16 v[192:207], v[40:43], v[252:255], v[192:207]
    s_waitcnt lgkmcnt(0)
    v_mfma_f32_32x32x16_bf16 v[208:223], v[44:47], v[252:255], v[208:223]
    v_mov_b32 v0, v18
    s_nop 1
    v_permlane32_swap_b32 v0, v18
    v_add_f32 v0, v0, v18
    v_rcp_f32 v0, v0
    s_cmp_eq_u32 s7, 3
    s_cbranch_scc0 K1_NOMASK
    s_mov_b32 exec_lo, 0xffff
    s_mov_b32 exec_hi, 0xffff
K1_NOMASK:
    v_mul_f32 v160, v0, v160
    v_mul_f32 v161, v0, v161
    v_mul_f32 v162, v0, v162
    v_mul_f32 v163, v0, v163
    v_mul_f32 v164, v0, v164
    v_mul_f32 v165, v0, v165
    v_mul_f32 v166, v0, v166
    v_mul_f32 v167, v0, v167
    v_cvt_pk_bf16_f32 v224, v160, v161
    v_cvt_pk_bf16_f32 v225, v162, v163
    v_cvt_pk_bf16_f32 v226, v164, v165
    v_cvt_pk_bf16_f32 v227, v166, v167
    buffer_store_dwordx4 v[224:227], v19, s[44:47], s53 offen offset:0 sc1
    v_mul_f32 v168, v0, v168
    v_mul_f32 v169, v0, v169
    v_mul_f32 v170, v0, v170
    v_mul_f32 v171, v0, v171
    v_mul_f32 v172, v0, v172
    v_mul_f32 v173, v0, v173
    v_mul_f32 v174, v0, v174
    v_mul_f32 v175, v0, v175
    v_cvt_pk_bf16_f32 v228, v168, v169
    v_cvt_pk_bf16_f32 v229, v170, v171
    v_cvt_pk_bf16_f32 v230, v172, v173
    v_cvt_pk_bf16_f32 v231, v174, v175
    buffer_store_dwordx4 v[228:231], v19, s[44:47], s53 offen offset:512 sc1
    v_mul_f32 v176, v0, v176
    v_mul_f32 v177, v0, v177
    v_mul_f32 v178, v0, v178
    v_mul_f32 v179, v0, v179
    v_mul_f32 v180, v0, v180
    v_mul_f32 v181, v0, v181
    v_mul_f32 v182, v0, v182
    v_mul_f32 v183, v0, v183
    v_cvt_pk_bf16_f32 v232, v176, v177
    v_cvt_pk_bf16_f32 v233, v178, v179
    v_cvt_pk_bf16_f32 v234, v180, v181
    v_cvt_pk_bf16_f32 v235, v182, v183
    buffer_store_dwordx4 v[232:235], v19, s[44:47], s53 offen offset:1024 sc1
    v_mul_f32 v184, v0, v184
    v_mul_f32 v185, v0, v185
    v_mul_f32 v186, v0, v186
    v_mul_f32 v187, v0, v187
    v_mul_f32 v188, v0, v188
    v_mul_f32 v189, v0, v189
    v_mul_f32 v190, v0, v190
    v_mul_f32 v191, v0, v191
    v_cvt_pk_bf16_f32 v236, v184, v185
    v_cvt_pk_bf16_f32 v237, v186, v187
    v_cvt_pk_bf16_f32 v238, v188, v189
    v_cvt_pk_bf16_f32 v239, v190, v191
    buffer_store_dwordx4 v[236:239], v19, s[44:47], s53 offen offset:1536 sc1
    v_mul_f32 v192, v0, v192
    v_mul_f32 v193, v0, v193
    v_mul_f32 v194, v0, v194
    v_mul_f32 v195, v0, v195
    v_mul_f32 v196, v0, v196
    v_mul_f32 v197, v0, v197
    v_mul_f32 v198, v0, v198
    v_mul_f32 v199, v0, v199
    v_cvt_pk_bf16_f32 v240, v192, v193
    v_cvt_pk_bf16_f32 v241, v194, v195
    v_cvt_pk_bf16_f32 v242, v196, v197
    v_cvt_pk_bf16_f32 v243, v198, v199
    buffer_store_dwordx4 v[240:243], v19, s[44:47], s53 offen offset:2048 sc1
    v_mul_f32 v200, v0, v200
    v_mul_f32 v201, v0, v201
    v_mul_f32 v202, v0, v202
    v_mul_f32 v203, v0, v203
    v_mul_f32 v204, v0, v204
    v_mul_f32 v205, v0, v205
    v_mul_f32 v206, v0, v206
    v_mul_f32 v207, v0, v207
    v_cvt_pk_bf16_f32 v244, v200, v201
    v_cvt_pk_bf16_f32 v245, v202, v203
    v_cvt_pk_bf16_f32 v246, v204, v205
    v_cvt_pk_bf16_f32 v247, v206, v207
    buffer_store_dwordx4 v[244:247], v19, s[44:47], s53 offen offset:2560 sc1
    v_mul_f32 v208, v0, v208
    v_mul_f32 v209, v0, v209
    v_mul_f32 v210, v0, v210
    v_mul_f32 v211, v0, v211
    v_mul_f32 v212, v0, v212
    v_mul_f32 v213, v0, v213
    v_mul_f32 v214, v0, v214
    v_mul_f32 v215, v0, v215
    v_cvt_pk_bf16_f32 v248, v208, v209
    v_cvt_pk_bf16_f32 v249, v210, v211
    v_cvt_pk_bf16_f32 v250, v212, v213
    v_cvt_pk_bf16_f32 v251, v214, v215
    buffer_store_dwordx4 v[248:251], v19, s[44:47], s53 offen offset:3072 sc1
    v_mul_f32 v216, v0, v216
    v_mul_f32 v217, v0, v217
    v_mul_f32 v218, v0, v218
    v_mul_f32 v219, v0, v219
    v_mul_f32 v220, v0, v220
    v_mul_f32 v221, v0, v221
    v_mul_f32 v222, v0, v222
    v_mul_f32 v223, v0, v223
    v_cvt_pk_bf16_f32 v252, v216, v217
    v_cvt_pk_bf16_f32 v253, v218, v219
    v_cvt_pk_bf16_f32 v254, v220, v221
    v_cvt_pk_bf16_f32 v255, v222, v223
    buffer_store_dwordx4 v[252:255], v19, s[44:47], s53 offen offset:3584 sc1
    s_mov_b64 exec, -1
    v_mbcnt_lo_u32_b32 v0, -1, 0
    v_mbcnt_hi_u32_b32 v0, -1, v0
    v_bfe_u32 v2, v0, 4, 1
    v_lshrrev_b32 v1, 5, v0
    v_bfe_u32 v3, v0, 2, 2
    v_and_b32 v4, 3, v0
    v_lshlrev_b32 v9, 17, v2
    v_lshl_add_u32 v9, v1, 8, v9
    v_and_b32 v8, 15, v0
    v_lshl_add_u32 v12, v8, 4, v9
    v_lshl_add_u32 v9, v1, 2, v3
    v_lshlrev_b32 v9, 7, v9
    v_lshrrev_b32 v8, 1, v4
    v_lshl_add_u32 v8, v2, 1, v8
    v_lshrrev_b32 v5, 1, v3
    v_lshlrev_b32 v5, 2, v5
    v_xor_b32 v8, v8, v5
    v_lshl_add_u32 v9, v8, 4, v9
    v_and_b32 v8, 1, v4
    v_lshl_add_u32 v9, v8, 3, v9
    v_add_u32 v13, s49, v9
    v_xor_b32 v14, 64, v13
    v_add_u32 v66, 65536, v13
    v_add_u32 v67, 65536, v14
    v_add_u32 v68, 131072, v13
    v_add_u32 v69, 131072, v14
    v_lshlrev_b32 v15, 4, v0
    s_lshl_b32 s12, s26, 6
    s_lshl_b32 s13, s4, 2
    s_add_u32 s12, s12, s13
    s_mov_b32 s13, 1
    v_mov_b32 v1, s12
    v_mov_b32 v2, s13
    v_mov_b32 v3, s11
    v_writelane_b32 v3, s10, 0
    v_mov_b32 v5, 1
    s_mov_b32 s14, 1
    s_mov_b32 s15, 0x40000
    s_waitcnt vmcnt(0)
    s_barrier
    s_cmp_eq_u32 s5, 0
    s_cbranch_scc0 K1_NOFLAG
    s_mov_b64 exec, 1
    buffer_atomic_add v2, v1, s[20:23], 0 offen sc0 sc1
    s_waitcnt vmcnt(0)
    v_cmp_eq_u32 vcc, 15, v2
    s_nop 1
    s_cbranch_vccz K1_NOFLAG
    buffer_store_dword v5, v1, s[20:23], 0 offen offset:128 sc1
K1_NOFLAG:
    s_cmp_ge_u32 s17, 252
    s_cbranch_scc1 K1_END
    s_mov_b64 exec, -1
    s_add_u32 s52, s50, 129024
    s_add_u32 m0, s49, 16384
    s_nop 0
    buffer_load_dwordx4 v6, s[28:31], s52 offen lds
    s_add_u32 s52, s50, 138240
    s_add_u32 m0, s49, 17408
    s_nop 0
    buffer_load_dwordx4 v6, s[28:31], s52 offen lds
    s_nop 15
    s_nop 7
    ds_read_b64_tr_b16 v[16:17], v66 offset:32768
    ds_read_b64_tr_b16 v[18:19], v66 offset:33792
    ds_read_b64_tr_b16 v[20:21], v67 offset:32768
    ds_read_b64_tr_b16 v[22:23], v67 offset:33792
    ds_read_b64_tr_b16 v[24:25], v66 offset:49152
    ds_read_b64_tr_b16 v[26:27], v66 offset:50176
    ds_read_b64_tr_b16 v[28:29], v67 offset:49152
    ds_read_b64_tr_b16 v[30:31], v67 offset:50176
    s_waitcnt lgkmcnt(0)
    ds_read_b64_tr_b16 v[32:33], v13 offset:32768
    ds_read_b64_tr_b16 v[34:35], v13 offset:33792
    ds_read_b64_tr_b16 v[36:37], v14 offset:32768
    ds_read_b64_tr_b16 v[38:39], v14 offset:33792
    ds_read_b64_tr_b16 v[40:41], v13 offset:49152
    ds_read_b64_tr_b16 v[42:43], v13 offset:50176
    ds_read_b64_tr_b16 v[44:45], v14 offset:49152
    ds_read_b64_tr_b16 v[46:47], v14 offset:50176
    s_waitcnt lgkmcnt(0)
    ds_read_b64_tr_b16 v[224:225], v68 offset:0
    ds_read_b64_tr_b16 v[226:227], v68 offset:1024
    ds_read_b64_tr_b16 v[228:229], v69 offset:0
    ds_read_b64_tr_b16 v[230:231], v69 offset:1024
    ds_read_b64_tr_b16 v[232:233], v68 offset:16384
    ds_read_b64_tr_b16 v[234:235], v68 offset:17408
    ds_read_b64_tr_b16 v[236:237], v69 offset:16384
    ds_read_b64_tr_b16 v[238:239], v69 offset:17408
    s_waitcnt lgkmcnt(0)
    s_add_u32 s52, s50, 147456
    s_add_u32 m0, s49, 98304
    s_nop 0
    buffer_load_dwordx4 v6, s[28:31], s52 offen lds
    s_add_u32 s52, s50, 156672
    s_add_u32 m0, s49, 99328
    s_nop 0
    buffer_load_dwordx4 v6, s[28:31], s52 offen lds
    s_add_u32 s52, s50, 165888
    s_add_u32 m0, s49, 114688
    s_nop 0
    buffer_load_dwordx4 v6, s[28:31], s52 offen lds
    s_add_u32 s52, s50, 175104
    s_add_u32 m0, s49, 115712
    s_nop 0
    buffer_load_dwordx4 v6, s[28:31], s52 offen lds
    s_add_u32 s52, s50, 184320
    s_add_u32 m0, s49, 32768
    s_nop 0
    buffer_load_dwordx4 v6, s[28:31], s52 offen lds
    s_add_u32 s52, s50, 193536
    s_add_u32 m0, s49, 33792
    s_nop 0
    buffer_load_dwordx4 v6, s[28:31], s52 offen lds
    s_add_u32 s52, s50, 202752
    s_add_u32 m0, s49, 49152
    s_nop 0
    buffer_load_dwordx4 v6, s[28:31], s52 offen lds
    s_add_u32 s52, s50, 211968
    s_add_u32 m0, s49, 50176
    s_nop 0
    buffer_load_dwordx4 v6, s[28:31], s52 offen lds
    s_add_u32 s52, s50, 221184
    s_add_u32 m0, s49, 131072
    s_nop 0
    buffer_load_dwordx4 v6, s[28:31], s52 offen lds
    s_add_u32 s52, s50, 230400
    s_add_u32 m0, s49, 132096
    s_nop 0
    buffer_load_dwordx4 v6, s[28:31], s52 offen lds
    s_add_u32 s52, s50, 239616
    s_add_u32 m0, s49, 147456
    s_nop 0
    buffer_load_dwordx4 v6, s[28:31], s52 offen lds
    s_add_u32 s52, s50, 248832
    s_add_u32 m0, s49, 148480
    s_nop 0
    buffer_load_dwordx4 v6, s[28:31], s52 offen lds
    s_waitcnt vmcnt(12)
    ds_read_b64_tr_b16 v[240:241], v13 offset:0
    ds_read_b64_tr_b16 v[242:243], v13 offset:1024
    ds_read_b64_tr_b16 v[244:245], v14 offset:0
    ds_read_b64_tr_b16 v[246:247], v14 offset:1024
    ds_read_b64_tr_b16 v[248:249], v13 offset:16384
    ds_read_b64_tr_b16 v[250:251], v13 offset:17408
    ds_read_b64_tr_b16 v[252:253], v14 offset:16384
    ds_read_b64_tr_b16 v[254:255], v14 offset:17408
    s_waitcnt lgkmcnt(0)
    s_waitcnt vmcnt(8)
    ds_read_b64_tr_b16 v[48:49], v66 offset:32768
    ds_read_b64_tr_b16 v[50:51], v66 offset:33792
    ds_read_b64_tr_b16 v[52:53], v67 offset:32768
    ds_read_b64_tr_b16 v[54:55], v67 offset:33792
    ds_read_b64_tr_b16 v[56:57], v66 offset:49152
    ds_read_b64_tr_b16 v[58:59], v66 offset:50176
    ds_read_b64_tr_b16 v[60:61], v67 offset:49152
    ds_read_b64_tr_b16 v[62:63], v67 offset:50176
    s_waitcnt lgkmcnt(0)
    s_waitcnt vmcnt(4)
    ds_read_b64_tr_b16 v[72:73], v13 offset:32768
    ds_read_b64_tr_b16 v[74:75], v13 offset:33792
    ds_read_b64_tr_b16 v[76:77], v14 offset:32768
    ds_read_b64_tr_b16 v[78:79], v14 offset:33792
    ds_read_b64_tr_b16 v[80:81], v13 offset:49152
    ds_read_b64_tr_b16 v[82:83], v13 offset:50176
    ds_read_b64_tr_b16 v[84:85], v14 offset:49152
    ds_read_b64_tr_b16 v[86:87], v14 offset:50176
    s_waitcnt lgkmcnt(0)
    s_cmp_eq_u32 s5, 0
    s_cbranch_scc0 K1_EP
    s_mov_b64 exec, 3
    buffer_load_dword v4, v3, s[20:23], 0 offen sc1
    s_mov_b64 exec, -1
K1_EP:
    s_add_u32 s52, s50, 258048
    s_add_u32 m0, s49, 0
    s_nop 0
    buffer_load_dwordx4 v6, s[28:31], s52 offen lds
    s_add_u32 s52, s50, 267264
    s_add_u32 m0, s49, 1024
    s_nop 0
    buffer_load_dwordx4 v6, s[28:31], s52 offen lds
    s_add_u32 s52, s50, 276480
    s_add_u32 m0, s49, 16384
    s_nop 0
    buffer_load_dwordx4 v6, s[28:31], s52 offen lds
    s_add_u32 s52, s50, 285696
    s_add_u32 m0, s49, 17408
    s_nop 0
    buffer_load_dwordx4 v6, s[28:31], s52 offen lds
    s_add_u32 s52, s50, 294912
    s_add_u32 m0, s49, 98304
    s_nop 0
    buffer_load_dwordx4 v6, s[28:31], s52 offen lds
    s_add_u32 s52, s50, 304128
    s_add_u32 m0, s49, 99328
    s_nop 0
    buffer_load_dwordx4 v6, s[28:31], s52 offen lds
    s_add_u32 s52, s50, 313344
    s_add_u32 m0, s49, 114688
    s_nop 0
    buffer_load_dwordx4 v6, s[28:31], s52 offen lds
    s_add_u32 s52, s50, 322560
    s_add_u32 m0, s49, 115712
    s_nop 0
    buffer_load_dwordx4 v6, s[28:31], s52 offen lds
    s_add_u32 s52, s50, 331776
    s_add_u32 m0, s49, 32768
    s_nop 0
    buffer_load_dwordx4 v6, s[28:31], s52 offen lds
    s_add_u32 s52, s50, 340992
    s_add_u32 m0, s49, 33792
    s_nop 0
    buffer_load_dwordx4 v6, s[28:31], s52 offen lds
    s_add_u32 s52, s50, 350208
    s_add_u32 m0, s49, 49152
    s_nop 0
    buffer_load_dwordx4 v6, s[28:31], s52 offen lds
    s_add_u32 s52, s50, 359424
    s_add_u32 m0, s49, 50176
    s_nop 0
    buffer_load_dwordx4 v6, s[28:31], s52 offen lds
    s_cmp_eq_u32 s5, 0
    s_cbranch_scc0 K1_GO
    s_mov_b64 exec, 3
    s_waitcnt vmcnt(12)
    v_and_b32 v4, s14, v4
    v_cmp_ne_u32 vcc, s14, v4
    s_nop 1
    s_cbranch_vccz K1_GO
K1_POLL:
    buffer_load_dword v4, v3, s[20:23], 0 offen sc1
    s_waitcnt vmcnt(0)
    v_and_b32 v4, s14, v4
    v_cmp_ne_u32 vcc, s14, v4
    s_nop 1
    s_cbranch_vccz K1_GO
    s_sleep 16
    s_sub_u32 s15, s15, 1
    s_cmp_lg_u32 s15, 0
    s_cbranch_scc1 K1_POLL
K1_GO:
    s_mov_b64 exec, -1
    s_barrier
    buffer_load_dwordx4 v[96:99], v12, s[44:47], s8 offen offset:0 sc1
    buffer_load_dwordx4 v[100:103], v12, s[44:47], s9 offen offset:0 sc1
    buffer_load_dwordx4 v[104:107], v12, s[44:47], s8 offen offset:512 sc1
    buffer_load_dwordx4 v[108:111], v12, s[44:47], s9 offen offset:512 sc1
    buffer_load_dwordx4 v[112:115], v12, s[44:47], s8 offen offset:1024 sc1
    buffer_load_dwordx4 v[116:119], v12, s[44:47], s9 offen offset:1024 sc1
    buffer_load_dwordx4 v[120:123], v12, s[44:47], s8 offen offset:1536 sc1
    buffer_load_dwordx4 v[124:127], v12, s[44:47], s9 offen offset:1536 sc1
    buffer_load_dwordx4 v[128:131], v12, s[44:47], s8 offen offset:2048 sc1
    buffer_load_dwordx4 v[132:135], v12, s[44:47], s9 offen offset:2048 sc1
    buffer_load_dwordx4 v[136:139], v12, s[44:47], s8 offen offset:2560 sc1
    buffer_load_dwordx4 v[140:143], v12, s[44:47], s9 offen offset:2560 sc1
    buffer_load_dwordx4 v[144:147], v12, s[44:47], s8 offen offset:3072 sc1
    buffer_load_dwordx4 v[148:151], v12, s[44:47], s9 offen offset:3072 sc1
    buffer_load_dwordx4 v[152:155], v12, s[44:47], s8 offen offset:3584 sc1
    buffer_load_dwordx4 v[156:159], v12, s[44:47], s9 offen offset:3584 sc1
    s_waitcnt vmcnt(12)
    v_mfma_f32_32x32x16_bf16 v[160:175], v[16:19], v[96:99], 0
    v_mfma_f32_32x32x16_bf16 v[176:191], v[16:19], v[100:103], 0
    v_mfma_f32_32x32x16_bf16 v[192:207], v[20:23], v[96:99], 0
    v_mfma_f32_32x32x16_bf16 v[208:223], v[20:23], v[100:103], 0
    v_mfma_f32_32x32x16_bf16 v[160:175], v[24:27], v[104:107], v[160:175]
    v_mfma_f32_32x32x16_bf16 v[176:191], v[24:27], v[108:111], v[176:191]
    v_mfma_f32_32x32x16_bf16 v[192:207], v[28:31], v[104:107], v[192:207]
    v_mfma_f32_32x32x16_bf16 v[208:223], v[28:31], v[108:111], v[208:223]
    s_add_u32 s52, s8, 4096
    buffer_load_dwordx4 v[96:99], v12, s[44:47], s52 offen offset:0 sc1
    s_add_u32 s52, s9, 4096
    buffer_load_dwordx4 v[100:103], v12, s[44:47], s52 offen offset:0 sc1
    s_add_u32 s52, s8, 4096
    buffer_load_dwordx4 v[104:107], v12, s[44:47], s52 offen offset:512 sc1
    s_add_u32 s52, s9, 4096
    buffer_load_dwordx4 v[108:111], v12, s[44:47], s52 offen offset:512 sc1
    s_waitcnt vmcnt(12)
    v_mfma_f32_32x32x16_bf16 v[160:175], v[32:35], v[112:115], v[160:175]
    v_mfma_f32_32x32x16_bf16 v[176:191], v[32:35], v[116:119], v[176:191]
    v_mfma_f32_32x32x16_bf16 v[192:207], v[36:39], v[112:115], v[192:207]
    v_mfma_f32_32x32x16_bf16 v[208:223], v[36:39], v[116:119], v[208:223]
    v_mfma_f32_32x32x16_bf16 v[160:175], v[40:43], v[120:123], v[160:175]
    v_mfma_f32_32x32x16_bf16 v[176:191], v[40:43], v[124:127], v[176:191]
    v_mfma_f32_32x32x16_bf16 v[192:207], v[44:47], v[120:123], v[192:207]
    v_mfma_f32_32x32x16_bf16 v[208:223], v[44:47], v[124:127], v[208:223]
    s_add_u32 s52, s8, 4096
    buffer_load_dwordx4 v[112:115], v12, s[44:47], s52 offen offset:1024 sc1
    s_add_u32 s52, s9, 4096
    buffer_load_dwordx4 v[116:119], v12, s[44:47], s52 offen offset:1024 sc1
    s_add_u32 s52, s8, 4096
    buffer_load_dwordx4 v[120:123], v12, s[44:47], s52 offen offset:1536 sc1
    s_add_u32 s52, s9, 4096
    buffer_load_dwordx4 v[124:127], v12, s[44:47], s52 offen offset:1536 sc1
    s_waitcnt vmcnt(12)
    v_mfma_f32_32x32x16_bf16 v[160:175], v[224:227], v[128:131], v[160:175]
    v_mfma_f32_32x32x16_bf16 v[176:191], v[224:227], v[132:135], v[176:191]
    v_mfma_f32_32x32x16_bf16 v[192:207], v[228:231], v[128:131], v[192:207]
    v_mfma_f32_32x32x16_bf16 v[208:223], v[228:231], v[132:135], v[208:223]
    v_mfma_f32_32x32x16_bf16 v[160:175], v[232:235], v[136:139], v[160:175]
    v_mfma_f32_32x32x16_bf16 v[176:191], v[232:235], v[140:143], v[176:191]
    v_mfma_f32_32x32x16_bf16 v[192:207], v[236:239], v[136:139], v[192:207]
    v_mfma_f32_32x32x16_bf16 v[208:223], v[236:239], v[140:143], v[208:223]
    s_add_u32 s52, s8, 4096
    buffer_load_dwordx4 v[128:131], v12, s[44:47], s52 offen offset:2048 sc1
    s_add_u32 s52, s9, 4096
    buffer_load_dwordx4 v[132:135], v12, s[44:47], s52 offen offset:2048 sc1
    s_add_u32 s52, s8, 4096
    buffer_load_dwordx4 v[136:139], v12, s[44:47], s52 offen offset:2560 sc1
    s_add_u32 s52, s9, 4096
    buffer_load_dwordx4 v[140:143], v12, s[44:47], s52 offen offset:2560 sc1
    s_waitcnt vmcnt(12)
    v_mfma_f32_32x32x16_bf16 v[160:175], v[240:243], v[144:147], v[160:175]
    v_mfma_f32_32x32x16_bf16 v[176:191], v[240:243], v[148:151], v[176:191]
    v_mfma_f32_32x32x16_bf16 v[192:207], v[244:247], v[144:147], v[192:207]
    v_mfma_f32_32x32x16_bf16 v[208:223], v[244:247], v[148:151], v[208:223]
    v_mfma_f32_32x32x16_bf16 v[160:175], v[248:251], v[152:155], v[160:175]
    v_mfma_f32_32x32x16_bf16 v[176:191], v[248:251], v[156:159], v[176:191]
    v_mfma_f32_32x32x16_bf16 v[192:207], v[252:255], v[152:155], v[192:207]
    v_mfma_f32_32x32x16_bf16 v[208:223], v[252:255], v[156:159], v[208:223]
    s_add_u32 s52, s8, 4096
    buffer_load_dwordx4 v[144:147], v12, s[44:47], s52 offen offset:3072 sc1
    s_add_u32 s52, s9, 4096
    buffer_load_dwordx4 v[148:151], v12, s[44:47], s52 offen offset:3072 sc1
    s_add_u32 s52, s8, 4096
    buffer_load_dwordx4 v[152:155], v12, s[44:47], s52 offen offset:3584 sc1
    s_add_u32 s52, s9, 4096
    buffer_load_dwordx4 v[156:159], v12, s[44:47], s52 offen offset:3584 sc1
    s_waitcnt vmcnt(12)
    v_mfma_f32_32x32x16_bf16 v[160:175], v[48:51], v[96:99], v[160:175]
    v_mfma_f32_32x32x16_bf16 v[176:191], v[48:51], v[100:103], v[176:191]
    v_mfma_f32_32x32x16_bf16 v[192:207], v[52:55], v[96:99], v[192:207]
    v_mfma_f32_32x32x16_bf16 v[208:223], v[52:55], v[100:103], v[208:223]
    v_mfma_f32_32x32x16_bf16 v[160:175], v[56:59], v[104:107], v[160:175]
    v_mfma_f32_32x32x16_bf16 v[176:191], v[56:59], v[108:111], v[176:191]
    v_mfma_f32_32x32x16_bf16 v[192:207], v[60:63], v[104:107], v[192:207]
    v_mfma_f32_32x32x16_bf16 v[208:223], v[60:63], v[108:111], v[208:223]
    s_add_u32 s52, s8, 8192
    buffer_load_dwordx4 v[96:99], v12, s[44:47], s52 offen offset:0 sc1
    s_add_u32 s52, s9, 8192
    buffer_load_dwordx4 v[100:103], v12, s[44:47], s52 offen offset:0 sc1
    s_add_u32 s52, s8, 8192
    buffer_load_dwordx4 v[104:107], v12, s[44:47], s52 offen offset:512 sc1
    s_add_u32 s52, s9, 8192
    buffer_load_dwordx4 v[108:111], v12, s[44:47], s52 offen offset:512 sc1
    ds_read_b64_tr_b16 v[16:17], v68 offset:0
    ds_read_b64_tr_b16 v[18:19], v68 offset:1024
    ds_read_b64_tr_b16 v[20:21], v69 offset:0
    ds_read_b64_tr_b16 v[22:23], v69 offset:1024
    ds_read_b64_tr_b16 v[24:25], v68 offset:16384
    ds_read_b64_tr_b16 v[26:27], v68 offset:17408
    ds_read_b64_tr_b16 v[28:29], v69 offset:16384
    ds_read_b64_tr_b16 v[30:31], v69 offset:17408
    s_waitcnt vmcnt(12)
    v_mfma_f32_32x32x16_bf16 v[160:175], v[72:75], v[112:115], v[160:175]
    v_mfma_f32_32x32x16_bf16 v[176:191], v[72:75], v[116:119], v[176:191]
    v_mfma_f32_32x32x16_bf16 v[192:207], v[76:79], v[112:115], v[192:207]
    v_mfma_f32_32x32x16_bf16 v[208:223], v[76:79], v[116:119], v[208:223]
    v_mfma_f32_32x32x16_bf16 v[160:175], v[80:83], v[120:123], v[160:175]
    v_mfma_f32_32x32x16_bf16 v[176:191], v[80:83], v[124:127], v[176:191]
    v_mfma_f32_32x32x16_bf16 v[192:207], v[84:87], v[120:123], v[192:207]
    v_mfma_f32_32x32x16_bf16 v[208:223], v[84:87], v[124:127], v[208:223]
    s_add_u32 s52, s8, 8192
    buffer_load_dwordx4 v[112:115], v12, s[44:47], s52 offen offset:1024 sc1
    s_add_u32 s52, s9, 8192
    buffer_load_dwordx4 v[116:119], v12, s[44:47], s52 offen offset:1024 sc1
    s_add_u32 s52, s8, 8192
    buffer_load_dwordx4 v[120:123], v12, s[44:47], s52 offen offset:1536 sc1
    s_add_u32 s52, s9, 8192
    buffer_load_dwordx4 v[124:127], v12, s[44:47], s52 offen offset:1536 sc1
    s_waitcnt lgkmcnt(0)
    ds_read_b64_tr_b16 v[32:33], v13 offset:0
    ds_read_b64_tr_b16 v[34:35], v13 offset:1024
    ds_read_b64_tr_b16 v[36:37], v14 offset:0
    ds_read_b64_tr_b16 v[38:39], v14 offset:1024
    ds_read_b64_tr_b16 v[40:41], v13 offset:16384
    ds_read_b64_tr_b16 v[42:43], v13 offset:17408
    ds_read_b64_tr_b16 v[44:45], v14 offset:16384
    ds_read_b64_tr_b16 v[46:47], v14 offset:17408
    s_waitcnt vmcnt(12)
    v_mfma_f32_32x32x16_bf16 v[160:175], v[16:19], v[128:131], v[160:175]
    v_mfma_f32_32x32x16_bf16 v[176:191], v[16:19], v[132:135], v[176:191]
    v_mfma_f32_32x32x16_bf16 v[192:207], v[20:23], v[128:131], v[192:207]
    v_mfma_f32_32x32x16_bf16 v[208:223], v[20:23], v[132:135], v[208:223]
    v_mfma_f32_32x32x16_bf16 v[160:175], v[24:27], v[136:139], v[160:175]
    v_mfma_f32_32x32x16_bf16 v[176:191], v[24:27], v[140:143], v[176:191]
    v_mfma_f32_32x32x16_bf16 v[192:207], v[28:31], v[136:139], v[192:207]
    v_mfma_f32_32x32x16_bf16 v[208:223], v[28:31], v[140:143], v[208:223]
    s_add_u32 s52, s50, 368640
    s_add_u32 m0, s49, 131072
    s_nop 0
    buffer_load_dwordx4 v6, s[28:31], s52 offen lds
    s_add_u32 s52, s50, 377856
    s_add_u32 m0, s49, 132096
    s_nop 0
    buffer_load_dwordx4 v6, s[28:31], s52 offen lds
    s_add_u32 s52, s50, 387072
    s_add_u32 m0, s49, 147456
    s_nop 0
    buffer_load_dwordx4 v6, s[28:31], s52 offen lds
    s_add_u32 s52, s50, 396288
    s_add_u32 m0, s49, 148480
    s_nop 0
    buffer_load_dwordx4 v6, s[28:31], s52 offen lds
    s_add_u32 s52, s8, 8192
    buffer_load_dwordx4 v[128:131], v12, s[44:47], s52 offen offset:2048 sc1
    s_add_u32 s52, s9, 8192
    buffer_load_dwordx4 v[132:135], v12, s[44:47], s52 offen offset:2048 sc1
    s_add_u32 s52, s8, 8192
    buffer_load_dwordx4 v[136:139], v12, s[44:47], s52 offen offset:2560 sc1
    s_add_u32 s52, s9, 8192
    buffer_load_dwordx4 v[140:143], v12, s[44:47], s52 offen offset:2560 sc1
    s_waitcnt lgkmcnt(0)
    ds_read_b64_tr_b16 v[16:17], v66 offset:32768
    ds_read_b64_tr_b16 v[18:19], v66 offset:33792
    ds_read_b64_tr_b16 v[20:21], v67 offset:32768
    ds_read_b64_tr_b16 v[22:23], v67 offset:33792
    ds_read_b64_tr_b16 v[24:25], v66 offset:49152
    ds_read_b64_tr_b16 v[26:27], v66 offset:50176
    ds_read_b64_tr_b16 v[28:29], v67 offset:49152
    ds_read_b64_tr_b16 v[30:31], v67 offset:50176
    s_waitcnt vmcnt(16)
    v_mfma_f32_32x32x16_bf16 v[160:175], v[32:35], v[144:147], v[160:175]
    v_mfma_f32_32x32x16_bf16 v[176:191], v[32:35], v[148:151], v[176:191]
    v_mfma_f32_32x32x16_bf16 v[192:207], v[36:39], v[144:147], v[192:207]
    v_mfma_f32_32x32x16_bf16 v[208:223], v[36:39], v[148:151], v[208:223]
    v_mfma_f32_32x32x16_bf16 v[160:175], v[40:43], v[152:155], v[160:175]
    v_mfma_f32_32x32x16_bf16 v[176:191], v[40:43], v[156:159], v[176:191]
    v_mfma_f32_32x32x16_bf16 v[192:207], v[44:47], v[152:155], v[192:207]
    v_mfma_f32_32x32x16_bf16 v[208:223], v[44:47], v[156:159], v[208:223]
    s_add_u32 s52, s50, 405504
    s_add_u32 m0, s49, 0
    s_nop 0
    buffer_load_dwordx4 v6, s[28:31], s52 offen lds
    s_add_u32 s52, s50, 414720
    s_add_u32 m0, s49, 1024
    s_nop 0
    buffer_load_dwordx4 v6, s[28:31], s52 offen lds
    s_add_u32 s52, s50, 423936
    s_add_u32 m0, s49, 16384
    s_nop 0
    buffer_load_dwordx4 v6, s[28:31], s52 offen lds
    s_add_u32 s52, s50, 433152
    s_add_u32 m0, s49, 17408
    s_nop 0
    buffer_load_dwordx4 v6, s[28:31], s52 offen lds
    s_add_u32 s52, s8, 8192
    buffer_load_dwordx4 v[144:147], v12, s[44:47], s52 offen offset:3072 sc1
    s_add_u32 s52, s9, 8192
    buffer_load_dwordx4 v[148:151], v12, s[44:47], s52 offen offset:3072 sc1
    s_add_u32 s52, s8, 8192
    buffer_load_dwordx4 v[152:155], v12, s[44:47], s52 offen offset:3584 sc1
    s_add_u32 s52, s9, 8192
    buffer_load_dwordx4 v[156:159], v12, s[44:47], s52 offen offset:3584 sc1
    s_waitcnt lgkmcnt(0)
    ds_read_b64_tr_b16 v[32:33], v13 offset:32768
    ds_read_b64_tr_b16 v[34:35], v13 offset:33792
    ds_read_b64_tr_b16 v[36:37], v14 offset:32768
    ds_read_b64_tr_b16 v[38:39], v14 offset:33792
    ds_read_b64_tr_b16 v[40:41], v13 offset:49152
    ds_read_b64_tr_b16 v[42:43], v13 offset:50176
    ds_read_b64_tr_b16 v[44:45], v14 offset:49152
    ds_read_b64_tr_b16 v[46:47], v14 offset:50176
    s_waitcnt vmcnt(20)
    v_mfma_f32_32x32x16_bf16 v[160:175], v[16:19], v[96:99], v[160:175]
    v_mfma_f32_32x32x16_bf16 v[176:191], v[16:19], v[100:103], v[176:191]
    v_mfma_f32_32x32x16_bf16 v[192:207], v[20:23], v[96:99], v[192:207]
    v_mfma_f32_32x32x16_bf16 v[208:223], v[20:23], v[100:103], v[208:223]
    v_mfma_f32_32x32x16_bf16 v[160:175], v[24:27], v[104:107], v[160:175]
    v_mfma_f32_32x32x16_bf16 v[176:191], v[24:27], v[108:111], v[176:191]
    v_mfma_f32_32x32x16_bf16 v[192:207], v[28:31], v[104:107], v[192:207]
    v_mfma_f32_32x32x16_bf16 v[208:223], v[28:31], v[108:111], v[208:223]
    s_add_u32 s52, s50, 442368
    s_add_u32 m0, s49, 98304
    s_nop 0
    buffer_load_dwordx4 v6, s[28:31], s52 offen lds
    s_add_u32 s52, s50, 451584
    s_add_u32 m0, s49, 99328
    s_nop 0
    buffer_load_dwordx4 v6, s[28:31], s52 offen lds
    s_add_u32 s52, s50, 460800
    s_add_u32 m0, s49, 114688
    s_nop 0
    buffer_load_dwordx4 v6, s[28:31], s52 offen lds
    s_add_u32 s52, s50, 470016
    s_add_u32 m0, s49, 115712
    s_nop 0
    buffer_load_dwordx4 v6, s[28:31], s52 offen lds
    s_add_u32 s52, s8, 12288
    buffer_load_dwordx4 v[96:99], v12, s[44:47], s52 offen offset:0 sc1
    s_add_u32 s52, s9, 12288
    buffer_load_dwordx4 v[100:103], v12, s[44:47], s52 offen offset:0 sc1
    s_add_u32 s52, s8, 12288
    buffer_load_dwordx4 v[104:107], v12, s[44:47], s52 offen offset:512 sc1
    s_add_u32 s52, s9, 12288
    buffer_load_dwordx4 v[108:111], v12, s[44:47], s52 offen offset:512 sc1
    s_waitcnt lgkmcnt(0)
    s_waitcnt vmcnt(20)
    ds_read_b64_tr_b16 v[16:17], v68 offset:0
    ds_read_b64_tr_b16 v[18:19], v68 offset:1024
    ds_read_b64_tr_b16 v[20:21], v69 offset:0
    ds_read_b64_tr_b16 v[22:23], v69 offset:1024
    ds_read_b64_tr_b16 v[24:25], v68 offset:16384
    ds_read_b64_tr_b16 v[26:27], v68 offset:17408
    ds_read_b64_tr_b16 v[28:29], v69 offset:16384
    ds_read_b64_tr_b16 v[30:31], v69 offset:17408
    v_mfma_f32_32x32x16_bf16 v[160:175], v[32:35], v[112:115], v[160:175]
    v_mfma_f32_32x32x16_bf16 v[176:191], v[32:35], v[116:119], v[176:191]
    v_mfma_f32_32x32x16_bf16 v[192:207], v[36:39], v[112:115], v[192:207]
    v_mfma_f32_32x32x16_bf16 v[208:223], v[36:39], v[116:119], v[208:223]
    v_mfma_f32_32x32x16_bf16 v[160:175], v[40:43], v[120:123], v[160:175]
    v_mfma_f32_32x32x16_bf16 v[176:191], v[40:43], v[124:127], v[176:191]
    v_mfma_f32_32x32x16_bf16 v[192:207], v[44:47], v[120:123], v[192:207]
    v_mfma_f32_32x32x16_bf16 v[208:223], v[44:47], v[124:127], v[208:223]
    s_add_u32 s52, s50, 479232
    s_add_u32 m0, s49, 32768
    s_nop 0
    buffer_load_dwordx4 v6, s[28:31], s52 offen lds
    s_add_u32 s52, s50, 488448
    s_add_u32 m0, s49, 33792
    s_nop 0
    buffer_load_dwordx4 v6, s[28:31], s52 offen lds
    s_add_u32 s52, s50, 497664
    s_add_u32 m0, s49, 49152
    s_nop 0
    buffer_load_dwordx4 v6, s[28:31], s52 offen lds
    s_add_u32 s52, s50, 506880
    s_add_u32 m0, s49, 50176
    s_nop 0
    buffer_load_dwordx4 v6, s[28:31], s52 offen lds
    s_add_u32 s52, s8, 12288
    buffer_load_dwordx4 v[112:115], v12, s[44:47], s52 offen offset:1024 sc1
    s_add_u32 s52, s9, 12288
    buffer_load_dwordx4 v[116:119], v12, s[44:47], s52 offen offset:1024 sc1
    s_add_u32 s52, s8, 12288
    buffer_load_dwordx4 v[120:123], v12, s[44:47], s52 offen offset:1536 sc1
    s_add_u32 s52, s9, 12288
    buffer_load_dwordx4 v[124:127], v12, s[44:47], s52 offen offset:1536 sc1
    s_waitcnt lgkmcnt(0)
    s_waitcnt vmcnt(20)
    ds_read_b64_tr_b16 v[32:33], v13 offset:0
    ds_read_b64_tr_b16 v[34:35], v13 offset:1024
    ds_read_b64_tr_b16 v[36:37], v14 offset:0
    ds_read_b64_tr_b16 v[38:39], v14 offset:1024
    ds_read_b64_tr_b16 v[40:41], v13 offset:16384
    ds_read_b64_tr_b16 v[42:43], v13 offset:17408
    ds_read_b64_tr_b16 v[44:45], v14 offset:16384
    ds_read_b64_tr_b16 v[46:47], v14 offset:17408
    v_mfma_f32_32x32x16_bf16 v[160:175], v[16:19], v[128:131], v[160:175]
    v_mfma_f32_32x32x16_bf16 v[176:191], v[16:19], v[132:135], v[176:191]
    v_mfma_f32_32x32x16_bf16 v[192:207], v[20:23], v[128:131], v[192:207]
    v_mfma_f32_32x32x16_bf16 v[208:223], v[20:23], v[132:135], v[208:223]
    v_mfma_f32_32x32x16_bf16 v[160:175], v[24:27], v[136:139], v[160:175]
    v_mfma_f32_32x32x16_bf16 v[176:191], v[24:27], v[140:143], v[176:191]
    v_mfma_f32_32x32x16_bf16 v[192:207], v[28:31], v[136:139], v[192:207]
    v_mfma_f32_32x32x16_bf16 v[208:223], v[28:31], v[140:143], v[208:223]
    s_add_u32 s52, s50, 516096
    s_add_u32 m0, s49, 131072
    s_nop 0
    buffer_load_dwordx4 v6, s[28:31], s52 offen lds
    s_add_u32 s52, s50, 525312
    s_add_u32 m0, s49, 132096
    s_nop 0
    buffer_load_dwordx4 v6, s[28:31], s52 offen lds
    s_add_u32 s52, s50, 534528
    s_add_u32 m0, s49, 147456
    s_nop 0
    buffer_load_dwordx4 v6, s[28:31], s52 offen lds
    s_add_u32 s52, s50, 543744
    s_add_u32 m0, s49, 148480
    s_nop 0
    buffer_load_dwordx4 v6, s[28:31], s52 offen lds
    s_add_u32 s52, s8, 12288
    buffer_load_dwordx4 v[128:131], v12, s[44:47], s52 offen offset:2048 sc1
    s_add_u32 s52, s9, 12288
    buffer_load_dwordx4 v[132:135], v12, s[44:47], s52 offen offset:2048 sc1
    s_add_u32 s52, s8, 12288
    buffer_load_dwordx4 v[136:139], v12, s[44:47], s52 offen offset:2560 sc1
    s_add_u32 s52, s9, 12288
    buffer_load_dwordx4 v[140:143], v12, s[44:47], s52 offen offset:2560 sc1
    s_waitcnt lgkmcnt(0)
    s_waitcnt vmcnt(20)
    ds_read_b64_tr_b16 v[16:17], v66 offset:32768
    ds_read_b64_tr_b16 v[18:19], v66 offset:33792
    ds_read_b64_tr_b16 v[20:21], v67 offset:32768
    ds_read_b64_tr_b16 v[22:23], v67 offset:33792
    ds_read_b64_tr_b16 v[24:25], v66 offset:49152
    ds_read_b64_tr_b16 v[26:27], v66 offset:50176
    ds_read_b64_tr_b16 v[28:29], v67 offset:49152
    ds_read_b64_tr_b16 v[30:31], v67 offset:50176
    v_mfma_f32_32x32x16_bf16 v[160:175], v[32:35], v[144:147], v[160:175]
    v_mfma_f32_32x32x16_bf16 v[176:191], v[32:35], v[148:151], v[176:191]
    v_mfma_f32_32x32x16_bf16 v[192:207], v[36:39], v[144:147], v[192:207]
    v_mfma_f32_32x32x16_bf16 v[208:223], v[36:39], v[148:151], v[208:223]
    v_mfma_f32_32x32x16_bf16 v[160:175], v[40:43], v[152:155], v[160:175]
    v_mfma_f32_32x32x16_bf16 v[176:191], v[40:43], v[156:159], v[176:191]
    v_mfma_f32_32x32x16_bf16 v[192:207], v[44:47], v[152:155], v[192:207]
    v_mfma_f32_32x32x16_bf16 v[208:223], v[44:47], v[156:159], v[208:223]
    s_add_u32 s52, s50, 552960
    s_add_u32 m0, s49, 0
    s_nop 0
    buffer_load_dwordx4 v6, s[28:31], s52 offen lds
    s_add_u32 s52, s50, 562176
    s_add_u32 m0, s49, 1024
    s_nop 0
    buffer_load_dwordx4 v6, s[28:31], s52 offen lds
    s_add_u32 s52, s50, 571392
    s_add_u32 m0, s49, 16384
    s_nop 0
    buffer_load_dwordx4 v6, s[28:31], s52 offen lds
    s_add_u32 s52, s50, 580608
    s_add_u32 m0, s49, 17408
    s_nop 0
    buffer_load_dwordx4 v6, s[28:31], s52 offen lds
    s_add_u32 s52, s8, 12288
    buffer_load_dwordx4 v[144:147], v12, s[44:47], s52 offen offset:3072 sc1
    s_add_u32 s52, s9, 12288
    buffer_load_dwordx4 v[148:151], v12, s[44:47], s52 offen offset:3072 sc1
    s_add_u32 s52, s8, 12288
    buffer_load_dwordx4 v[152:155], v12, s[44:47], s52 offen offset:3584 sc1
    s_add_u32 s52, s9, 12288
    buffer_load_dwordx4 v[156:159], v12, s[44:47], s52 offen offset:3584 sc1
    s_waitcnt lgkmcnt(0)
    s_waitcnt vmcnt(20)
    ds_read_b64_tr_b16 v[32:33], v13 offset:32768
    ds_read_b64_tr_b16 v[34:35], v13 offset:33792
    ds_read_b64_tr_b16 v[36:37], v14 offset:32768
    ds_read_b64_tr_b16 v[38:39], v14 offset:33792
    ds_read_b64_tr_b16 v[40:41], v13 offset:49152
    ds_read_b64_tr_b16 v[42:43], v13 offset:50176
    ds_read_b64_tr_b16 v[44:45], v14 offset:49152
    ds_read_b64_tr_b16 v[46:47], v14 offset:50176
    v_mfma_f32_32x32x16_bf16 v[160:175], v[16:19], v[96:99], v[160:175]
    v_mfma_f32_32x32x16_bf16 v[176:191], v[16:19], v[100:103], v[176:191]
    v_mfma_f32_32x32x16_bf16 v[192:207], v[20:23], v[96:99], v[192:207]
    v_mfma_f32_32x32x16_bf16 v[208:223], v[20:23], v[100:103], v[208:223]
    v_mfma_f32_32x32x16_bf16 v[160:175], v[24:27], v[104:107], v[160:175]
    v_mfma_f32_32x32x16_bf16 v[176:191], v[24:27], v[108:111], v[176:191]
    v_mfma_f32_32x32x16_bf16 v[192:207], v[28:31], v[104:107], v[192:207]
    v_mfma_f32_32x32x16_bf16 v[208:223], v[28:31], v[108:111], v[208:223]
    s_waitcnt lgkmcnt(0)
    s_waitcnt vmcnt(12)
    ds_read_b64_tr_b16 v[16:17], v68 offset:0
    ds_read_b64_tr_b16 v[18:19], v68 offset:1024
    ds_read_b64_tr_b16 v[20:21], v69 offset:0
    ds_read_b64_tr_b16 v[22:23], v69 offset:1024
    ds_read_b64_tr_b16 v[24:25], v68 offset:16384
    ds_read_b64_tr_b16 v[26:27], v68 offset:17408
    ds_read_b64_tr_b16 v[28:29], v69 offset:16384
    ds_read_b64_tr_b16 v[30:31], v69 offset:17408
    v_mfma_f32_32x32x16_bf16 v[160:175], v[32:35], v[112:115], v[160:175]
    v_mfma_f32_32x32x16_bf16 v[176:191], v[32:35], v[116:119], v[176:191]
    v_mfma_f32_32x32x16_bf16 v[192:207], v[36:39], v[112:115], v[192:207]
    v_mfma_f32_32x32x16_bf16 v[208:223], v[36:39], v[116:119], v[208:223]
    v_mfma_f32_32x32x16_bf16 v[160:175], v[40:43], v[120:123], v[160:175]
    v_mfma_f32_32x32x16_bf16 v[176:191], v[40:43], v[124:127], v[176:191]
    v_mfma_f32_32x32x16_bf16 v[192:207], v[44:47], v[120:123], v[192:207]
    v_mfma_f32_32x32x16_bf16 v[208:223], v[44:47], v[124:127], v[208:223]
    s_waitcnt lgkmcnt(0)
    s_waitcnt vmcnt(4)
    ds_read_b64_tr_b16 v[32:33], v13 offset:0
    ds_read_b64_tr_b16 v[34:35], v13 offset:1024
    ds_read_b64_tr_b16 v[36:37], v14 offset:0
    ds_read_b64_tr_b16 v[38:39], v14 offset:1024
    ds_read_b64_tr_b16 v[40:41], v13 offset:16384
    ds_read_b64_tr_b16 v[42:43], v13 offset:17408
    ds_read_b64_tr_b16 v[44:45], v14 offset:16384
    ds_read_b64_tr_b16 v[46:47], v14 offset:17408
    v_mfma_f32_32x32x16_bf16 v[160:175], v[16:19], v[128:131], v[160:175]
    v_mfma_f32_32x32x16_bf16 v[176:191], v[16:19], v[132:135], v[176:191]
    v_mfma_f32_32x32x16_bf16 v[192:207], v[20:23], v[128:131], v[192:207]
    v_mfma_f32_32x32x16_bf16 v[208:223], v[20:23], v[132:135], v[208:223]
    v_mfma_f32_32x32x16_bf16 v[160:175], v[24:27], v[136:139], v[160:175]
    v_mfma_f32_32x32x16_bf16 v[176:191], v[24:27], v[140:143], v[176:191]
    v_mfma_f32_32x32x16_bf16 v[192:207], v[28:31], v[136:139], v[192:207]
    v_mfma_f32_32x32x16_bf16 v[208:223], v[28:31], v[140:143], v[208:223]
    s_waitcnt lgkmcnt(0)
    s_waitcnt vmcnt(0)
    v_mfma_f32_32x32x16_bf16 v[160:175], v[32:35], v[144:147], v[160:175]
    v_mfma_f32_32x32x16_bf16 v[176:191], v[32:35], v[148:151], v[176:191]
    v_mfma_f32_32x32x16_bf16 v[192:207], v[36:39], v[144:147], v[192:207]
    v_mfma_f32_32x32x16_bf16 v[208:223], v[36:39], v[148:151], v[208:223]
    v_mfma_f32_32x32x16_bf16 v[160:175], v[40:43], v[152:155], v[160:175]
    v_mfma_f32_32x32x16_bf16 v[176:191], v[40:43], v[156:159], v[176:191]
    v_mfma_f32_32x32x16_bf16 v[192:207], v[44:47], v[152:155], v[192:207]
    v_mfma_f32_32x32x16_bf16 v[208:223], v[44:47], v[156:159], v[208:223]
    v_add_u32 v1, s49, v15
    v_add_u32 v2, 0x10000, v1
    v_add_u32 v3, 0x20000, v1
    s_nop 5
    ds_write_b128 v2, v[160:163] offset:32768
    ds_write_b128 v2, v[164:167] offset:33792
    ds_write_b128 v2, v[168:171] offset:49152
    ds_write_b128 v2, v[172:175] offset:50176
    ds_write_b128 v1, v[176:179] offset:32768
    ds_write_b128 v1, v[180:183] offset:33792
    ds_write_b128 v1, v[184:187] offset:49152
    ds_write_b128 v1, v[188:191] offset:50176
    ds_write_b128 v3, v[192:195] offset:0
    ds_write_b128 v3, v[196:199] offset:1024
    ds_write_b128 v3, v[200:203] offset:16384
    ds_write_b128 v3, v[204:207] offset:17408
    ds_write_b128 v1, v[208:211] offset:0
    ds_write_b128 v1, v[212:215] offset:1024
    ds_write_b128 v1, v[216:219] offset:16384
    ds_write_b128 v1, v[220:223] offset:17408
    s_lshl_b32 s6, s5, 2
    s_lshr_b32 s6, 0x10983276, s6
    s_and_b32 s6, s6, 15
    s_lshl_b32 s6, s6, 14
    v_add_u32 v4, s6, v15
    s_waitcnt lgkmcnt(0)
    s_barrier
    ds_read_b128 v[96:99], v4 offset:0
    ds_read_b128 v[100:103], v4 offset:1024
    ds_read_b128 v[104:107], v4 offset:2048
    ds_read_b128 v[108:111], v4 offset:3072
    ds_read_b128 v[112:115], v4 offset:4096
    ds_read_b128 v[116:119], v4 offset:5120
    ds_read_b128 v[120:123], v4 offset:6144
    ds_read_b128 v[124:127], v4 offset:7168
    ds_read_b128 v[128:131], v4 offset:8192
    ds_read_b128 v[132:135], v4 offset:9216
    ds_read_b128 v[136:139], v4 offset:10240
    ds_read_b128 v[140:143], v4 offset:11264
    s_waitcnt lgkmcnt(0)
    ds_read_b128 v[144:147], v4 offset:12288
    ds_read_b128 v[148:151], v4 offset:13312
    ds_read_b128 v[152:155], v4 offset:14336
    ds_read_b128 v[156:159], v4 offset:15360
    s_waitcnt lgkmcnt(0)
    v_add_f32 v96, v96, v104
    v_add_f32 v97, v97, v105
    v_add_f32 v98, v98, v106
    v_add_f32 v99, v99, v107
    v_add_f32 v100, v100, v108
    v_add_f32 v101, v101, v109
    v_add_f32 v102, v102, v110
    v_add_f32 v103, v103, v111
    v_add_f32 v96, v96, v112
    v_add_f32 v97, v97, v113
    v_add_f32 v98, v98, v114
    v_add_f32 v99, v99, v115
    v_add_f32 v100, v100, v116
    v_add_f32 v101, v101, v117
    v_add_f32 v102, v102, v118
    v_add_f32 v103, v103, v119
    v_add_f32 v96, v96, v120
    v_add_f32 v97, v97, v121
    v_add_f32 v98, v98, v122
    v_add_f32 v99, v99, v123
    v_add_f32 v100, v100, v124
    v_add_f32 v101, v101, v125
    v_add_f32 v102, v102, v126
    v_add_f32 v103, v103, v127
    v_add_f32 v96, v96, v128
    v_add_f32 v97, v97, v129
    v_add_f32 v98, v98, v130
    v_add_f32 v99, v99, v131
    v_add_f32 v100, v100, v132
    v_add_f32 v101, v101, v133
    v_add_f32 v102, v102, v134
    v_add_f32 v103, v103, v135
    v_add_f32 v96, v96, v136
    v_add_f32 v97, v97, v137
    v_add_f32 v98, v98, v138
    v_add_f32 v99, v99, v139
    v_add_f32 v100, v100, v140
    v_add_f32 v101, v101, v141
    v_add_f32 v102, v102, v142
    v_add_f32 v103, v103, v143
    v_add_f32 v96, v96, v144
    v_add_f32 v97, v97, v145
    v_add_f32 v98, v98, v146
    v_add_f32 v99, v99, v147
    v_add_f32 v100, v100, v148
    v_add_f32 v101, v101, v149
    v_add_f32 v102, v102, v150
    v_add_f32 v103, v103, v151
    v_add_f32 v96, v96, v152
    v_add_f32 v97, v97, v153
    v_add_f32 v98, v98, v154
    v_add_f32 v99, v99, v155
    v_add_f32 v100, v100, v156
    v_add_f32 v101, v101, v157
    v_add_f32 v102, v102, v158
    v_add_f32 v103, v103, v159
    v_cvt_pk_bf16_f32 v16, v96, v97
    v_cvt_pk_bf16_f32 v17, v98, v99
    v_cvt_pk_bf16_f32 v18, v100, v101
    v_cvt_pk_bf16_f32 v19, v102, v103
    s_lshr_b32 s6, s5, 1
    s_and_b32 s7, s6, 1
    s_lshr_b32 s6, s6, 1
    s_lshl_b32 s3, s18, 6
    s_lshl_b32 s7, s7, 5
    s_add_u32 s3, s3, s7
    s_mul_i32 s3, s3, 2304
    s_mul_i32 s7, s16, 1152
    s_add_u32 s3, s3, s7
    s_lshl_b32 s7, s19, 7
    s_add_u32 s3, s3, s7
    s_lshl_b32 s7, s6, 6
    s_add_u32 s3, s3, s7
    s_and_b32 s7, s5, 1
    s_lshl_b32 s7, s7, 5
    s_add_u32 s3, s3, s7
    v_and_b32 v1, 31, v0
    v_mul_u32_u24 v1, 2304, v1
    v_lshrrev_b32 v2, 5, v0
    v_lshl_add_u32 v1, v2, 3, v1
    buffer_store_dwordx2 v[16:17], v1, s[32:35], s3 offen
    buffer_store_dwordx2 v[18:19], v1, s[32:35], s3 offen offset:16
K1_END:
    s_endpgm
K1_SLOW1:
    s_nop 15
    s_nop 7
    v_max3_f32 v22, v128, v129, v130
    v_max3_f32 v23, v131, v132, v133
    v_max3_f32 v22, v22, v134, v135
    v_max3_f32 v23, v23, v136, v137
    v_max3_f32 v22, v22, v138, v139
    v_max3_f32 v23, v23, v140, v141
    v_max3_f32 v22, v22, v142, v143
    v_max3_f32 v23, v23, v144, v145
    v_max3_f32 v22, v22, v146, v147
    v_max3_f32 v23, v23, v148, v149
    v_max3_f32 v22, v22, v150, v151
    v_max3_f32 v23, v23, v152, v153
    v_max3_f32 v22, v22, v154, v155
    v_max3_f32 v23, v23, v156, v157
    v_max3_f32 v22, v22, v158, v159
    v_max_f32 v22, v22, v23
    v_mov_b32 v23, v22
    s_nop 1
    v_permlane32_swap_b32 v22, v23
    v_max_f32 v22, v22, v23
    v_max_f32 v22, 0, v22
    v_sub_f32 v23, 0, v22
    v_exp_f32 v23, v23
    s_nop 0
    v_mul_f32 v160, v23, v160
    v_mul_f32 v161, v23, v161
    v_mul_f32 v162, v23, v162
    v_mul_f32 v163, v23, v163
    v_mul_f32 v164, v23, v164
    v_mul_f32 v165, v23, v165
    v_mul_f32 v166, v23, v166
    v_mul_f32 v167, v23, v167
    v_mul_f32 v168, v23, v168
    v_mul_f32 v169, v23, v169
    v_mul_f32 v170, v23, v170
    v_mul_f32 v171, v23, v171
    v_mul_f32 v172, v23, v172
    v_mul_f32 v173, v23, v173
    v_mul_f32 v174, v23, v174
    v_mul_f32 v175, v23, v175
    v_mul_f32 v176, v23, v176
    v_mul_f32 v177, v23, v177
    v_mul_f32 v178, v23, v178
    v_mul_f32 v179, v23, v179
    v_mul_f32 v180, v23, v180
    v_mul_f32 v181, v23, v181
    v_mul_f32 v182, v23, v182
    v_mul_f32 v183, v23, v183
    v_mul_f32 v184, v23, v184
    v_mul_f32 v185, v23, v185
    v_mul_f32 v186, v23, v186
    v_mul_f32 v187, v23, v187
    v_mul_f32 v188, v23, v188
    v_mul_f32 v189, v23, v189
    v_mul_f32 v190, v23, v190
    v_mul_f32 v191, v23, v191
    v_mul_f32 v192, v23, v192
    v_mul_f32 v193, v23, v193
    v_mul_f32 v194, v23, v194
    v_mul_f32 v195, v23, v195
    v_mul_f32 v196, v23, v196
    v_mul_f32 v197, v23, v197
    v_mul_f32 v198, v23, v198
    v_mul_f32 v199, v23, v199
    v_mul_f32 v200, v23, v200
    v_mul_f32 v201, v23, v201
    v_mul_f32 v202, v23, v202
    v_mul_f32 v203, v23, v203
    v_mul_f32 v204, v23, v204
    v_mul_f32 v205, v23, v205
    v_mul_f32 v206, v23, v206
    v_mul_f32 v207, v23, v207
    v_mul_f32 v208, v23, v208
    v_mul_f32 v209, v23, v209
    v_mul_f32 v210, v23, v210
    v_mul_f32 v211, v23, v211
    v_mul_f32 v212, v23, v212
    v_mul_f32 v213, v23, v213
    v_mul_f32 v214, v23, v214
    v_mul_f32 v215, v23, v215
    v_mul_f32 v216, v23, v216
    v_mul_f32 v217, v23, v217
    v_mul_f32 v218, v23, v218
    v_mul_f32 v219, v23, v219
    v_mul_f32 v220, v23, v220
    v_mul_f32 v221, v23, v221
    v_mul_f32 v222, v23, v222
    v_mul_f32 v223, v23, v223
    v_mul_f32 v18, v23, v18
    v_sub_f32 v48, v48, v22
    v_sub_f32 v49, v49, v22
    v_sub_f32 v50, v50, v22
    v_sub_f32 v51, v51, v22
    v_sub_f32 v52, v52, v22
    v_sub_f32 v53, v53, v22
    v_sub_f32 v54, v54, v22
    v_sub_f32 v55, v55, v22
    v_sub_f32 v56, v56, v22
    v_sub_f32 v57, v57, v22
    v_sub_f32 v58, v58, v22
    v_sub_f32 v59, v59, v22
    v_sub_f32 v60, v60, v22
    v_sub_f32 v61, v61, v22
    v_sub_f32 v62, v62, v22
    v_sub_f32 v63, v63, v22
    v_sub_f32 v96, v96, v22
    v_sub_f32 v97, v97, v22
    v_sub_f32 v98, v98, v22
    v_sub_f32 v99, v99, v22
    v_sub_f32 v100, v100, v22
    v_sub_f32 v101, v101, v22
    v_sub_f32 v102, v102, v22
    v_sub_f32 v103, v103, v22
    v_sub_f32 v104, v104, v22
    v_sub_f32 v105, v105, v22
    v_sub_f32 v106, v106, v22
    v_sub_f32 v107, v107, v22
    v_sub_f32 v108, v108, v22
    v_sub_f32 v109, v109, v22
    v_sub_f32 v110, v110, v22
    v_sub_f32 v111, v111, v22
    v_sub_f32 v112, v112, v22
    v_sub_f32 v113, v113, v22
    v_sub_f32 v114, v114, v22
    v_sub_f32 v115, v115, v22
    v_sub_f32 v116, v116, v22
    v_sub_f32 v117, v117, v22
    v_sub_f32 v118, v118, v22
    v_sub_f32 v119, v119, v22
    v_sub_f32 v120, v120, v22
    v_sub_f32 v121, v121, v22
    v_sub_f32 v122, v122, v22
    v_sub_f32 v123, v123, v22
    v_sub_f32 v124, v124, v22
    v_sub_f32 v125, v125, v22
    v_sub_f32 v126, v126, v22
    v_sub_f32 v127, v127, v22
    v_sub_f32 v128, v128, v22
    v_sub_f32 v129, v129, v22
    v_exp_f32 v0, v128
    v_sub_f32 v130, v130, v22
    v_exp_f32 v1, v129
    v_mov_b32 v20, v0
    v_sub_f32 v131, v131, v22
    v_exp_f32 v2, v130
    v_mov_b32 v21, v1
    v_cvt_pk_bf16_f32 v240, v0, v1
    v_sub_f32 v132, v132, v22
    v_exp_f32 v3, v131
    v_add_f32 v20, v20, v2
    v_sub_f32 v133, v133, v22
    v_exp_f32 v0, v132
    v_add_f32 v21, v21, v3
    v_cvt_pk_bf16_f32 v241, v2, v3
    v_sub_f32 v134, v134, v22
    v_exp_f32 v1, v133
    v_add_f32 v20, v20, v0
    v_sub_f32 v135, v135, v22
    v_exp_f32 v2, v134
    v_add_f32 v21, v21, v1
    v_cvt_pk_bf16_f32 v242, v0, v1
    v_sub_f32 v136, v136, v22
    v_exp_f32 v3, v135
    v_add_f32 v20, v20, v2
    v_sub_f32 v137, v137, v22
    v_exp_f32 v0, v136
    v_add_f32 v21, v21, v3
    v_cvt_pk_bf16_f32 v243, v2, v3
    v_sub_f32 v138, v138, v22
    v_exp_f32 v1, v137
    v_add_f32 v20, v20, v0
    v_sub_f32 v139, v139, v22
    v_exp_f32 v2, v138
    v_add_f32 v21, v21, v1
    v_cvt_pk_bf16_f32 v244, v0, v1
    v_sub_f32 v140, v140, v22
    v_exp_f32 v3, v139
    v_add_f32 v20, v20, v2
    v_sub_f32 v141, v141, v22
    v_exp_f32 v0, v140
    v_add_f32 v21, v21, v3
    v_cvt_pk_bf16_f32 v245, v2, v3
    v_sub_f32 v142, v142, v22
    v_exp_f32 v1, v141
    v_add_f32 v20, v20, v0
    v_sub_f32 v143, v143, v22
    v_exp_f32 v2, v142
    v_add_f32 v21, v21, v1
    v_cvt_pk_bf16_f32 v246, v0, v1
    v_sub_f32 v144, v144, v22
    v_exp_f32 v3, v143
    v_add_f32 v20, v20, v2
    v_sub_f32 v145, v145, v22
    v_exp_f32 v0, v144
    v_add_f32 v21, v21, v3
    v_cvt_pk_bf16_f32 v247, v2, v3
    v_sub_f32 v146, v146, v22
    v_exp_f32 v1, v145
    v_add_f32 v20, v20, v0
    v_sub_f32 v147, v147, v22
    v_exp_f32 v2, v146
    v_add_f32 v21, v21, v1
    v_cvt_pk_bf16_f32 v248, v0, v1
    v_sub_f32 v148, v148, v22
    v_exp_f32 v3, v147
    v_add_f32 v20, v20, v2
    v_sub_f32 v149, v149, v22
    v_exp_f32 v0, v148
    v_add_f32 v21, v21, v3
    v_cvt_pk_bf16_f32 v249, v2, v3
    v_sub_f32 v150, v150, v22
    v_exp_f32 v1, v149
    v_add_f32 v20, v20, v0
    v_sub_f32 v151, v151, v22
    v_exp_f32 v2, v150
    v_add_f32 v21, v21, v1
    v_cvt_pk_bf16_f32 v250, v0, v1
    v_sub_f32 v152, v152, v22
    v_exp_f32 v3, v151
    v_add_f32 v20, v20, v2
    v_sub_f32 v153, v153, v22
    v_exp_f32 v0, v152
    v_add_f32 v21, v21, v3
    v_cvt_pk_bf16_f32 v251, v2, v3
    v_sub_f32 v154, v154, v22
    v_exp_f32 v1, v153
    v_add_f32 v20, v20, v0
    v_sub_f32 v155, v155, v22
    v_exp_f32 v2, v154
    v_add_f32 v21, v21, v1
    v_cvt_pk_bf16_f32 v252, v0, v1
    v_sub_f32 v156, v156, v22
    v_exp_f32 v3, v155
    v_add_f32 v20, v20, v2
    v_sub_f32 v157, v157, v22
    v_exp_f32 v0, v156
    v_add_f32 v21, v21, v3
    v_cvt_pk_bf16_f32 v253, v2, v3
    v_sub_f32 v158, v158, v22
    v_exp_f32 v1, v157
    v_add_f32 v20, v20, v0
    v_sub_f32 v159, v159, v22
    v_exp_f32 v2, v158
    v_add_f32 v21, v21, v1
    v_cvt_pk_bf16_f32 v254, v0, v1
    v_exp_f32 v3, v159
    v_add_f32 v20, v20, v2
    v_add_f32 v21, v21, v3
    v_cvt_pk_bf16_f32 v255, v2, v3
    v_add_f32 v20, v20, v21
    s_nop 15
    s_nop 7
    s_branch K1_BACK1
K1_SLOW2:
    s_nop 15
    s_nop 7
    v_max3_f32 v22, v96, v97, v98
    v_max3_f32 v23, v99, v100, v101
    v_max3_f32 v22, v22, v102, v103
    v_max3_f32 v23, v23, v104, v105
    v_max3_f32 v22, v22, v106, v107
    v_max3_f32 v23, v23, v108, v109
    v_max3_f32 v22, v22, v110, v111
    v_max3_f32 v23, v23, v112, v113
    v_max3_f32 v22, v22, v114, v115
    v_max3_f32 v23, v23, v116, v117
    v_max3_f32 v22, v22, v118, v119
    v_max3_f32 v23, v23, v120, v121
    v_max3_f32 v22, v22, v122, v123
    v_max3_f32 v23, v23, v124, v125
    v_max3_f32 v22, v22, v126, v127
    v_max_f32 v22, v22, v23
    v_mov_b32 v23, v22
    s_nop 1
    v_permlane32_swap_b32 v22, v23
    v_max_f32 v22, v22, v23
    v_max_f32 v22, 0, v22
    v_sub_f32 v23, 0, v22
    v_exp_f32 v23, v23
    s_nop 0
    v_mul_f32 v160, v23, v160
    v_mul_f32 v161, v23, v161
    v_mul_f32 v162, v23, v162
    v_mul_f32 v163, v23, v163
    v_mul_f32 v164, v23, v164
    v_mul_f32 v165, v23, v165
    v_mul_f32 v166, v23, v166
    v_mul_f32 v167, v23, v167
    v_mul_f32 v168, v23, v168
    v_mul_f32 v169, v23, v169
    v_mul_f32 v170, v23, v170
    v_mul_f32 v171, v23, v171
    v_mul_f32 v172, v23, v172
    v_mul_f32 v173, v23, v173
    v_mul_f32 v174, v23, v174
    v_mul_f32 v175, v23, v175
    v_mul_f32 v176, v23, v176
    v_mul_f32 v177, v23, v177
    v_mul_f32 v178, v23, v178
    v_mul_f32 v179, v23, v179
    v_mul_f32 v180, v23, v180
    v_mul_f32 v181, v23, v181
    v_mul_f32 v182, v23, v182
    v_mul_f32 v183, v23, v183
    v_mul_f32 v184, v23, v184
    v_mul_f32 v185, v23, v185
    v_mul_f32 v186, v23, v186
    v_mul_f32 v187, v23, v187
    v_mul_f32 v188, v23, v188
    v_mul_f32 v189, v23, v189
    v_mul_f32 v190, v23, v190
    v_mul_f32 v191, v23, v191
    v_mul_f32 v192, v23, v192
    v_mul_f32 v193, v23, v193
    v_mul_f32 v194, v23, v194
    v_mul_f32 v195, v23, v195
    v_mul_f32 v196, v23, v196
    v_mul_f32 v197, v23, v197
    v_mul_f32 v198, v23, v198
    v_mul_f32 v199, v23, v199
    v_mul_f32 v200, v23, v200
    v_mul_f32 v201, v23, v201
    v_mul_f32 v202, v23, v202
    v_mul_f32 v203, v23, v203
    v_mul_f32 v204, v23, v204
    v_mul_f32 v205, v23, v205
    v_mul_f32 v206, v23, v206
    v_mul_f32 v207, v23, v207
    v_mul_f32 v208, v23, v208
    v_mul_f32 v209, v23, v209
    v_mul_f32 v210, v23, v210
    v_mul_f32 v211, v23, v211
    v_mul_f32 v212, v23, v212
    v_mul_f32 v213, v23, v213
    v_mul_f32 v214, v23, v214
    v_mul_f32 v215, v23, v215
    v_mul_f32 v216, v23, v216
    v_mul_f32 v217, v23, v217
    v_mul_f32 v218, v23, v218
    v_mul_f32 v219, v23, v219
    v_mul_f32 v220, v23, v220
    v_mul_f32 v221, v23, v221
    v_mul_f32 v222, v23, v222
    v_mul_f32 v223, v23, v223
    v_mul_f32 v18, v23, v18
    v_sub_f32 v48, v48, v22
    v_sub_f32 v49, v49, v22
    v_sub_f32 v50, v50, v22
    v_sub_f32 v51, v51, v22
    v_sub_f32 v52, v52, v22
    v_sub_f32 v53, v53, v22
    v_sub_f32 v54, v54, v22
    v_sub_f32 v55, v55, v22
    v_sub_f32 v56, v56, v22
    v_sub_f32 v57, v57, v22
    v_sub_f32 v58, v58, v22
    v_sub_f32 v59, v59, v22
    v_sub_f32 v60, v60, v22
    v_sub_f32 v61, v61, v22
    v_sub_f32 v62, v62, v22
    v_sub_f32 v63, v63, v22
    v_sub_f32 v128, v128, v22
    v_sub_f32 v129, v129, v22
    v_sub_f32 v130, v130, v22
    v_sub_f32 v131, v131, v22
    v_sub_f32 v132, v132, v22
    v_sub_f32 v133, v133, v22
    v_sub_f32 v134, v134, v22
    v_sub_f32 v135, v135, v22
    v_sub_f32 v136, v136, v22
    v_sub_f32 v137, v137, v22
    v_sub_f32 v138, v138, v22
    v_sub_f32 v139, v139, v22
    v_sub_f32 v140, v140, v22
    v_sub_f32 v141, v141, v22
    v_sub_f32 v142, v142, v22
    v_sub_f32 v143, v143, v22
    v_sub_f32 v144, v144, v22
    v_sub_f32 v145, v145, v22
    v_sub_f32 v146, v146, v22
    v_sub_f32 v147, v147, v22
    v_sub_f32 v148, v148, v22
    v_sub_f32 v149, v149, v22
    v_sub_f32 v150, v150, v22
    v_sub_f32 v151, v151, v22
    v_sub_f32 v152, v152, v22
    v_sub_f32 v153, v153, v22
    v_sub_f32 v154, v154, v22
    v_sub_f32 v155, v155, v22
    v_sub_f32 v156, v156, v22
    v_sub_f32 v157, v157, v22
    v_sub_f32 v158, v158, v22
    v_sub_f32 v159, v159, v22
    v_sub_f32 v96, v96, v22
    v_sub_f32 v97, v97, v22
    v_exp_f32 v0, v96
    v_sub_f32 v98, v98, v22
    v_exp_f32 v1, v97
    v_mov_b32 v20, v0
    v_sub_f32 v99, v99, v22
    v_exp_f32 v2, v98
    v_mov_b32 v21, v1
    v_cvt_pk_bf16_f32 v224, v0, v1
    v_sub_f32 v100, v100, v22
    v_exp_f32 v3, v99
    v_add_f32 v20, v20, v2
    v_sub_f32 v101, v101, v22
    v_exp_f32 v0, v100
    v_add_f32 v21, v21, v3
    v_cvt_pk_bf16_f32 v225, v2, v3
    v_sub_f32 v102, v102, v22
    v_exp_f32 v1, v101
    v_add_f32 v20, v20, v0
    v_sub_f32 v103, v103, v22
    v_exp_f32 v2, v102
    v_add_f32 v21, v21, v1
    v_cvt_pk_bf16_f32 v226, v0, v1
    v_sub_f32 v104, v104, v22
    v_exp_f32 v3, v103
    v_add_f32 v20, v20, v2
    v_sub_f32 v105, v105, v22
    v_exp_f32 v0, v104
    v_add_f32 v21, v21, v3
    v_cvt_pk_bf16_f32 v227, v2, v3
    v_sub_f32 v106, v106, v22
    v_exp_f32 v1, v105
    v_add_f32 v20, v20, v0
    v_sub_f32 v107, v107, v22
    v_exp_f32 v2, v106
    v_add_f32 v21, v21, v1
    v_cvt_pk_bf16_f32 v228, v0, v1
    v_sub_f32 v108, v108, v22
    v_exp_f32 v3, v107
    v_add_f32 v20, v20, v2
    v_sub_f32 v109, v109, v22
    v_exp_f32 v0, v108
    v_add_f32 v21, v21, v3
    v_cvt_pk_bf16_f32 v229, v2, v3
    v_sub_f32 v110, v110, v22
    v_exp_f32 v1, v109
    v_add_f32 v20, v20, v0
    v_sub_f32 v111, v111, v22
    v_exp_f32 v2, v110
    v_add_f32 v21, v21, v1
    v_cvt_pk_bf16_f32 v230, v0, v1
    v_sub_f32 v112, v112, v22
    v_exp_f32 v3, v111
    v_add_f32 v20, v20, v2
    v_sub_f32 v113, v113, v22
    v_exp_f32 v0, v112
    v_add_f32 v21, v21, v3
    v_cvt_pk_bf16_f32 v231, v2, v3
    v_sub_f32 v114, v114, v22
    v_exp_f32 v1, v113
    v_add_f32 v20, v20, v0
    v_sub_f32 v115, v115, v22
    v_exp_f32 v2, v114
    v_add_f32 v21, v21, v1
    v_cvt_pk_bf16_f32 v232, v0, v1
    v_sub_f32 v116, v116, v22
    v_exp_f32 v3, v115
    v_add_f32 v20, v20, v2
    v_sub_f32 v117, v117, v22
    v_exp_f32 v0, v116
    v_add_f32 v21, v21, v3
    v_cvt_pk_bf16_f32 v233, v2, v3
    v_sub_f32 v118, v118, v22
    v_exp_f32 v1, v117
    v_add_f32 v20, v20, v0
    v_sub_f32 v119, v119, v22
    v_exp_f32 v2, v118
    v_add_f32 v21, v21, v1
    v_cvt_pk_bf16_f32 v234, v0, v1
    v_sub_f32 v120, v120, v22
    v_exp_f32 v3, v119
    v_add_f32 v20, v20, v2
    v_sub_f32 v121, v121, v22
    v_exp_f32 v0, v120
    v_add_f32 v21, v21, v3
    v_cvt_pk_bf16_f32 v235, v2, v3
    v_sub_f32 v122, v122, v22
    v_exp_f32 v1, v121
    v_add_f32 v20, v20, v0
    v_sub_f32 v123, v123, v22
    v_exp_f32 v2, v122
    v_add_f32 v21, v21, v1
    v_cvt_pk_bf16_f32 v236, v0, v1
    v_sub_f32 v124, v124, v22
    v_exp_f32 v3, v123
    v_add_f32 v20, v20, v2
    v_sub_f32 v125, v125, v22
    v_exp_f32 v0, v124
    v_add_f32 v21, v21, v3
    v_cvt_pk_bf16_f32 v237, v2, v3
    v_sub_f32 v126, v126, v22
    v_exp_f32 v1, v125
    v_add_f32 v20, v20, v0
    v_sub_f32 v127, v127, v22
    v_exp_f32 v2, v126
    v_add_f32 v21, v21, v1
    v_cvt_pk_bf16_f32 v238, v0, v1
    v_exp_f32 v3, v127
    v_add_f32 v20, v20, v2
    v_add_f32 v21, v21, v3
    v_cvt_pk_bf16_f32 v239, v2, v3
    v_add_f32 v20, v20, v21
    s_nop 15
    s_nop 7
    s_branch K1_BACK2
K1_SLOW3:
    s_nop 15
    s_nop 7
    v_max3_f32 v22, v128, v129, v130
    v_max3_f32 v23, v131, v132, v133
    v_max3_f32 v22, v22, v134, v135
    v_max3_f32 v23, v23, v136, v137
    v_max3_f32 v22, v22, v138, v139
    v_max3_f32 v23, v23, v140, v141
    v_max3_f32 v22, v22, v142, v143
    v_max3_f32 v23, v23, v144, v145
    v_max3_f32 v22, v22, v146, v147
    v_max3_f32 v23, v23, v148, v149
    v_max3_f32 v22, v22, v150, v151
    v_max3_f32 v23, v23, v152, v153
    v_max3_f32 v22, v22, v154, v155
    v_max3_f32 v23, v23, v156, v157
    v_max3_f32 v22, v22, v158, v159
    v_max_f32 v22, v22, v23
    v_mov_b32 v23, v22
    s_nop 1
    v_permlane32_swap_b32 v22, v23
    v_max_f32 v22, v22, v23
    v_max_f32 v22, 0, v22
    v_sub_f32 v23, 0, v22
    v_exp_f32 v23, v23
    s_nop 0
    v_mul_f32 v160, v23, v160
    v_mul_f32 v161, v23, v161
    v_mul_f32 v162, v23, v162
    v_mul_f32 v163, v23, v163
    v_mul_f32 v164, v23, v164
    v_mul_f32 v165, v23, v165
    v_mul_f32 v166, v23, v166
    v_mul_f32 v167, v23, v167
    v_mul_f32 v168, v23, v168
    v_mul_f32 v169, v23, v169
    v_mul_f32 v170, v23, v170
    v_mul_f32 v171, v23, v171
    v_mul_f32 v172, v23, v172
    v_mul_f32 v173, v23, v173
    v_mul_f32 v174, v23, v174
    v_mul_f32 v175, v23, v175
    v_mul_f32 v176, v23, v176
    v_mul_f32 v177, v23, v177
    v_mul_f32 v178, v23, v178
    v_mul_f32 v179, v23, v179
    v_mul_f32 v180, v23, v180
    v_mul_f32 v181, v23, v181
    v_mul_f32 v182, v23, v182
    v_mul_f32 v183, v23, v183
    v_mul_f32 v184, v23, v184
    v_mul_f32 v185, v23, v185
    v_mul_f32 v186, v23, v186
    v_mul_f32 v187, v23, v187
    v_mul_f32 v188, v23, v188
    v_mul_f32 v189, v23, v189
    v_mul_f32 v190, v23, v190
    v_mul_f32 v191, v23, v191
    v_mul_f32 v192, v23, v192
    v_mul_f32 v193, v23, v193
    v_mul_f32 v194, v23, v194
    v_mul_f32 v195, v23, v195
    v_mul_f32 v196, v23, v196
    v_mul_f32 v197, v23, v197
    v_mul_f32 v198, v23, v198
    v_mul_f32 v199, v23, v199
    v_mul_f32 v200, v23, v200
    v_mul_f32 v201, v23, v201
    v_mul_f32 v202, v23, v202
    v_mul_f32 v203, v23, v203
    v_mul_f32 v204, v23, v204
    v_mul_f32 v205, v23, v205
    v_mul_f32 v206, v23, v206
    v_mul_f32 v207, v23, v207
    v_mul_f32 v208, v23, v208
    v_mul_f32 v209, v23, v209
    v_mul_f32 v210, v23, v210
    v_mul_f32 v211, v23, v211
    v_mul_f32 v212, v23, v212
    v_mul_f32 v213, v23, v213
    v_mul_f32 v214, v23, v214
    v_mul_f32 v215, v23, v215
    v_mul_f32 v216, v23, v216
    v_mul_f32 v217, v23, v217
    v_mul_f32 v218, v23, v218
    v_mul_f32 v219, v23, v219
    v_mul_f32 v220, v23, v220
    v_mul_f32 v221, v23, v221
    v_mul_f32 v222, v23, v222
    v_mul_f32 v223, v23, v223
    v_mul_f32 v18, v23, v18
    v_sub_f32 v48, v48, v22
    v_sub_f32 v49, v49, v22
    v_sub_f32 v50, v50, v22
    v_sub_f32 v51, v51, v22
    v_sub_f32 v52, v52, v22
    v_sub_f32 v53, v53, v22
    v_sub_f32 v54, v54, v22
    v_sub_f32 v55, v55, v22
    v_sub_f32 v56, v56, v22
    v_sub_f32 v57, v57, v22
    v_sub_f32 v58, v58, v22
    v_sub_f32 v59, v59, v22
    v_sub_f32 v60, v60, v22
    v_sub_f32 v61, v61, v22
    v_sub_f32 v62, v62, v22
    v_sub_f32 v63, v63, v22
    v_sub_f32 v96, v96, v22
    v_sub_f32 v97, v97, v22
    v_sub_f32 v98, v98, v22
    v_sub_f32 v99, v99, v22
    v_sub_f32 v100, v100, v22
    v_sub_f32 v101, v101, v22
    v_sub_f32 v102, v102, v22
    v_sub_f32 v103, v103, v22
    v_sub_f32 v104, v104, v22
    v_sub_f32 v105, v105, v22
    v_sub_f32 v106, v106, v22
    v_sub_f32 v107, v107, v22
    v_sub_f32 v108, v108, v22
    v_sub_f32 v109, v109, v22
    v_sub_f32 v110, v110, v22
    v_sub_f32 v111, v111, v22
    v_sub_f32 v112, v112, v22
    v_sub_f32 v113, v113, v22
    v_sub_f32 v114, v114, v22
    v_sub_f32 v115, v115, v22
    v_sub_f32 v116, v116, v22
    v_sub_f32 v117, v117, v22
    v_sub_f32 v118, v118, v22
    v_sub_f32 v119, v119, v22
    v_sub_f32 v120, v120, v22
    v_sub_f32 v121, v121, v22
    v_sub_f32 v122, v122, v22
    v_sub_f32 v123, v123, v22
    v_sub_f32 v124, v124, v22
    v_sub_f32 v125, v125, v22
    v_sub_f32 v126, v126, v22
    v_sub_f32 v127, v127, v22
    v_sub_f32 v128, v128, v22
    v_sub_f32 v129, v129, v22
    v_exp_f32 v0, v128
    v_sub_f32 v130, v130, v22
    v_exp_f32 v1, v129
    v_mov_b32 v20, v0
    v_sub_f32 v131, v131, v22
    v_exp_f32 v2, v130
    v_mov_b32 v21, v1
    v_cvt_pk_bf16_f32 v240, v0, v1
    v_sub_f32 v132, v132, v22
    v_exp_f32 v3, v131
    v_add_f32 v20, v20, v2
    v_sub_f32 v133, v133, v22
    v_exp_f32 v0, v132
    v_add_f32 v21, v21, v3
    v_cvt_pk_bf16_f32 v241, v2, v3
    v_sub_f32 v134, v134, v22
    v_exp_f32 v1, v133
    v_add_f32 v20, v20, v0
    v_sub_f32 v135, v135, v22
    v_exp_f32 v2, v134
    v_add_f32 v21, v21, v1
    v_cvt_pk_bf16_f32 v242, v0, v1
    v_sub_f32 v136, v136, v22
    v_exp_f32 v3, v135
    v_add_f32 v20, v20, v2
    v_sub_f32 v137, v137, v22
    v_exp_f32 v0, v136
    v_add_f32 v21, v21, v3
    v_cvt_pk_bf16_f32 v243, v2, v3
    v_sub_f32 v138, v138, v22
    v_exp_f32 v1, v137
    v_add_f32 v20, v20, v0
    v_sub_f32 v139, v139, v22
    v_exp_f32 v2, v138
    v_add_f32 v21, v21, v1
    v_cvt_pk_bf16_f32 v244, v0, v1
    v_sub_f32 v140, v140, v22
    v_exp_f32 v3, v139
    v_add_f32 v20, v20, v2
    v_sub_f32 v141, v141, v22
    v_exp_f32 v0, v140
    v_add_f32 v21, v21, v3
    v_cvt_pk_bf16_f32 v245, v2, v3
    v_sub_f32 v142, v142, v22
    v_exp_f32 v1, v141
    v_add_f32 v20, v20, v0
    v_sub_f32 v143, v143, v22
    v_exp_f32 v2, v142
    v_add_f32 v21, v21, v1
    v_cvt_pk_bf16_f32 v246, v0, v1
    v_sub_f32 v144, v144, v22
    v_exp_f32 v3, v143
    v_add_f32 v20, v20, v2
    v_sub_f32 v145, v145, v22
    v_exp_f32 v0, v144
    v_add_f32 v21, v21, v3
    v_cvt_pk_bf16_f32 v247, v2, v3
    v_sub_f32 v146, v146, v22
    v_exp_f32 v1, v145
    v_add_f32 v20, v20, v0
    v_sub_f32 v147, v147, v22
    v_exp_f32 v2, v146
    v_add_f32 v21, v21, v1
    v_cvt_pk_bf16_f32 v248, v0, v1
    v_sub_f32 v148, v148, v22
    v_exp_f32 v3, v147
    v_add_f32 v20, v20, v2
    v_sub_f32 v149, v149, v22
    v_exp_f32 v0, v148
    v_add_f32 v21, v21, v3
    v_cvt_pk_bf16_f32 v249, v2, v3
    v_sub_f32 v150, v150, v22
    v_exp_f32 v1, v149
    v_add_f32 v20, v20, v0
    v_sub_f32 v151, v151, v22
    v_exp_f32 v2, v150
    v_add_f32 v21, v21, v1
    v_cvt_pk_bf16_f32 v250, v0, v1
    v_sub_f32 v152, v152, v22
    v_exp_f32 v3, v151
    v_add_f32 v20, v20, v2
    v_sub_f32 v153, v153, v22
    v_exp_f32 v0, v152
    v_add_f32 v21, v21, v3
    v_cvt_pk_bf16_f32 v251, v2, v3
    v_sub_f32 v154, v154, v22
    v_exp_f32 v1, v153
    v_add_f32 v20, v20, v0
    v_sub_f32 v155, v155, v22
    v_exp_f32 v2, v154
    v_add_f32 v21, v21, v1
    v_cvt_pk_bf16_f32 v252, v0, v1
    v_sub_f32 v156, v156, v22
    v_exp_f32 v3, v155
    v_add_f32 v20, v20, v2
    v_sub_f32 v157, v157, v22
    v_exp_f32 v0, v156
    v_add_f32 v21, v21, v3
    v_cvt_pk_bf16_f32 v253, v2, v3
    v_sub_f32 v158, v158, v22
    v_exp_f32 v1, v157
    v_add_f32 v20, v20, v0
    v_sub_f32 v159, v159, v22
    v_exp_f32 v2, v158
    v_add_f32 v21, v21, v1
    v_cvt_pk_bf16_f32 v254, v0, v1
    v_exp_f32 v3, v159
    v_add_f32 v20, v20, v2
    v_add_f32 v21, v21, v3
    v_cvt_pk_bf16_f32 v255, v2, v3
    v_add_f32 v20, v20, v21
    s_nop 15
    s_nop 7
    s_branch K1_BACK3
K1_SLOW4:
    s_nop 15
    s_nop 7
    v_max3_f32 v22, v96, v97, v98
    v_max3_f32 v23, v99, v100, v101
    v_max3_f32 v22, v22, v102, v103
    v_max3_f32 v23, v23, v104, v105
    v_max3_f32 v22, v22, v106, v107
    v_max3_f32 v23, v23, v108, v109
    v_max3_f32 v22, v22, v110, v111
    v_max3_f32 v23, v23, v112, v113
    v_max3_f32 v22, v22, v114, v115
    v_max3_f32 v23, v23, v116, v117
    v_max3_f32 v22, v22, v118, v119
    v_max3_f32 v23, v23, v120, v121
    v_max3_f32 v22, v22, v122, v123
    v_max3_f32 v23, v23, v124, v125
    v_max3_f32 v22, v22, v126, v127
    v_max_f32 v22, v22, v23
    v_mov_b32 v23, v22
    s_nop 1
    v_permlane32_swap_b32 v22, v23
    v_max_f32 v22, v22, v23
    v_max_f32 v22, 0, v22
    v_sub_f32 v23, 0, v22
    v_exp_f32 v23, v23
    s_nop 0
    v_mul_f32 v160, v23, v160
    v_mul_f32 v161, v23, v161
    v_mul_f32 v162, v23, v162
    v_mul_f32 v163, v23, v163
    v_mul_f32 v164, v23, v164
    v_mul_f32 v165, v23, v165
    v_mul_f32 v166, v23, v166
    v_mul_f32 v167, v23, v167
    v_mul_f32 v168, v23, v168
    v_mul_f32 v169, v23, v169
    v_mul_f32 v170, v23, v170
    v_mul_f32 v171, v23, v171
    v_mul_f32 v172, v23, v172
    v_mul_f32 v173, v23, v173
    v_mul_f32 v174, v23, v174
    v_mul_f32 v175, v23, v175
    v_mul_f32 v176, v23, v176
    v_mul_f32 v177, v23, v177
    v_mul_f32 v178, v23, v178
    v_mul_f32 v179, v23, v179
    v_mul_f32 v180, v23, v180
    v_mul_f32 v181, v23, v181
    v_mul_f32 v182, v23, v182
    v_mul_f32 v183, v23, v183
    v_mul_f32 v184, v23, v184
    v_mul_f32 v185, v23, v185
    v_mul_f32 v186, v23, v186
    v_mul_f32 v187, v23, v187
    v_mul_f32 v188, v23, v188
    v_mul_f32 v189, v23, v189
    v_mul_f32 v190, v23, v190
    v_mul_f32 v191, v23, v191
    v_mul_f32 v192, v23, v192
    v_mul_f32 v193, v23, v193
    v_mul_f32 v194, v23, v194
    v_mul_f32 v195, v23, v195
    v_mul_f32 v196, v23, v196
    v_mul_f32 v197, v23, v197
    v_mul_f32 v198, v23, v198
    v_mul_f32 v199, v23, v199
    v_mul_f32 v200, v23, v200
    v_mul_f32 v201, v23, v201
    v_mul_f32 v202, v23, v202
    v_mul_f32 v203, v23, v203
    v_mul_f32 v204, v23, v204
    v_mul_f32 v205, v23, v205
    v_mul_f32 v206, v23, v206
    v_mul_f32 v207, v23, v207
    v_mul_f32 v208, v23, v208
    v_mul_f32 v209, v23, v209
    v_mul_f32 v210, v23, v210
    v_mul_f32 v211, v23, v211
    v_mul_f32 v212, v23, v212
    v_mul_f32 v213, v23, v213
    v_mul_f32 v214, v23, v214
    v_mul_f32 v215, v23, v215
    v_mul_f32 v216, v23, v216
    v_mul_f32 v217, v23, v217
    v_mul_f32 v218, v23, v218
    v_mul_f32 v219, v23, v219
    v_mul_f32 v220, v23, v220
    v_mul_f32 v221, v23, v221
    v_mul_f32 v222, v23, v222
    v_mul_f32 v223, v23, v223
    v_mul_f32 v18, v23, v18
    v_sub_f32 v48, v48, v22
    v_sub_f32 v49, v49, v22
    v_sub_f32 v50, v50, v22
    v_sub_f32 v51, v51, v22
    v_sub_f32 v52, v52, v22
    v_sub_f32 v53, v53, v22
    v_sub_f32 v54, v54, v22
    v_sub_f32 v55, v55, v22
    v_sub_f32 v56, v56, v22
    v_sub_f32 v57, v57, v22
    v_sub_f32 v58, v58, v22
    v_sub_f32 v59, v59, v22
    v_sub_f32 v60, v60, v22
    v_sub_f32 v61, v61, v22
    v_sub_f32 v62, v62, v22
    v_sub_f32 v63, v63, v22
    v_sub_f32 v128, v128, v22
    v_sub_f32 v129, v129, v22
    v_sub_f32 v130, v130, v22
    v_sub_f32 v131, v131, v22
    v_sub_f32 v132, v132, v22
    v_sub_f32 v133, v133, v22
    v_sub_f32 v134, v134, v22
    v_sub_f32 v135, v135, v22
    v_sub_f32 v136, v136, v22
    v_sub_f32 v137, v137, v22
    v_sub_f32 v138, v138, v22
    v_sub_f32 v139, v139, v22
    v_sub_f32 v140, v140, v22
    v_sub_f32 v141, v141, v22
    v_sub_f32 v142, v142, v22
    v_sub_f32 v143, v143, v22
    v_sub_f32 v144, v144, v22
    v_sub_f32 v145, v145, v22
    v_sub_f32 v146, v146, v22
    v_sub_f32 v147, v147, v22
    v_sub_f32 v148, v148, v22
    v_sub_f32 v149, v149, v22
    v_sub_f32 v150, v150, v22
    v_sub_f32 v151, v151, v22
    v_sub_f32 v152, v152, v22
    v_sub_f32 v153, v153, v22
    v_sub_f32 v154, v154, v22
    v_sub_f32 v155, v155, v22
    v_sub_f32 v156, v156, v22
    v_sub_f32 v157, v157, v22
    v_sub_f32 v158, v158, v22
    v_sub_f32 v159, v159, v22
    v_sub_f32 v96, v96, v22
    v_sub_f32 v97, v97, v22
    v_exp_f32 v0, v96
    v_sub_f32 v98, v98, v22
    v_exp_f32 v1, v97
    v_mov_b32 v20, v0
    v_sub_f32 v99, v99, v22
    v_exp_f32 v2, v98
    v_mov_b32 v21, v1
    v_cvt_pk_bf16_f32 v224, v0, v1
    v_sub_f32 v100, v100, v22
    v_exp_f32 v3, v99
    v_add_f32 v20, v20, v2
    v_sub_f32 v101, v101, v22
    v_exp_f32 v0, v100
    v_add_f32 v21, v21, v3
    v_cvt_pk_bf16_f32 v225, v2, v3
    v_sub_f32 v102, v102, v22
    v_exp_f32 v1, v101
    v_add_f32 v20, v20, v0
    v_sub_f32 v103, v103, v22
    v_exp_f32 v2, v102
    v_add_f32 v21, v21, v1
    v_cvt_pk_bf16_f32 v226, v0, v1
    v_sub_f32 v104, v104, v22
    v_exp_f32 v3, v103
    v_add_f32 v20, v20, v2
    v_sub_f32 v105, v105, v22
    v_exp_f32 v0, v104
    v_add_f32 v21, v21, v3
    v_cvt_pk_bf16_f32 v227, v2, v3
    v_sub_f32 v106, v106, v22
    v_exp_f32 v1, v105
    v_add_f32 v20, v20, v0
    v_sub_f32 v107, v107, v22
    v_exp_f32 v2, v106
    v_add_f32 v21, v21, v1
    v_cvt_pk_bf16_f32 v228, v0, v1
    v_sub_f32 v108, v108, v22
    v_exp_f32 v3, v107
    v_add_f32 v20, v20, v2
    v_sub_f32 v109, v109, v22
    v_exp_f32 v0, v108
    v_add_f32 v21, v21, v3
    v_cvt_pk_bf16_f32 v229, v2, v3
    v_sub_f32 v110, v110, v22
    v_exp_f32 v1, v109
    v_add_f32 v20, v20, v0
    v_sub_f32 v111, v111, v22
    v_exp_f32 v2, v110
    v_add_f32 v21, v21, v1
    v_cvt_pk_bf16_f32 v230, v0, v1
    v_sub_f32 v112, v112, v22
    v_exp_f32 v3, v111
    v_add_f32 v20, v20, v2
    v_sub_f32 v113, v113, v22
    v_exp_f32 v0, v112
    v_add_f32 v21, v21, v3
    v_cvt_pk_bf16_f32 v231, v2, v3
    v_sub_f32 v114, v114, v22
    v_exp_f32 v1, v113
    v_add_f32 v20, v20, v0
    v_sub_f32 v115, v115, v22
    v_exp_f32 v2, v114
    v_add_f32 v21, v21, v1
    v_cvt_pk_bf16_f32 v232, v0, v1
    v_sub_f32 v116, v116, v22
    v_exp_f32 v3, v115
    v_add_f32 v20, v20, v2
    v_sub_f32 v117, v117, v22
    v_exp_f32 v0, v116
    v_add_f32 v21, v21, v3
    v_cvt_pk_bf16_f32 v233, v2, v3
    v_sub_f32 v118, v118, v22
    v_exp_f32 v1, v117
    v_add_f32 v20, v20, v0
    v_sub_f32 v119, v119, v22
    v_exp_f32 v2, v118
    v_add_f32 v21, v21, v1
    v_cvt_pk_bf16_f32 v234, v0, v1
    v_sub_f32 v120, v120, v22
    v_exp_f32 v3, v119
    v_add_f32 v20, v20, v2
    v_sub_f32 v121, v121, v22
    v_exp_f32 v0, v120
    v_add_f32 v21, v21, v3
    v_cvt_pk_bf16_f32 v235, v2, v3
    v_sub_f32 v122, v122, v22
    v_exp_f32 v1, v121
    v_add_f32 v20, v20, v0
    v_sub_f32 v123, v123, v22
    v_exp_f32 v2, v122
    v_add_f32 v21, v21, v1
    v_cvt_pk_bf16_f32 v236, v0, v1
    v_sub_f32 v124, v124, v22
    v_exp_f32 v3, v123
    v_add_f32 v20, v20, v2
    v_sub_f32 v125, v125, v22
    v_exp_f32 v0, v124
    v_add_f32 v21, v21, v3
    v_cvt_pk_bf16_f32 v237, v2, v3
    v_sub_f32 v126, v126, v22
    v_exp_f32 v1, v125
    v_add_f32 v20, v20, v0
    v_sub_f32 v127, v127, v22
    v_exp_f32 v2, v126
    v_add_f32 v21, v21, v1
    v_cvt_pk_bf16_f32 v238, v0, v1
    v_exp_f32 v3, v127
    v_add_f32 v20, v20, v2
    v_add_f32 v21, v21, v3
    v_cvt_pk_bf16_f32 v239, v2, v3
    v_add_f32 v20, v20, v21
    s_nop 15
    s_nop 7
    s_branch K1_BACK4
K1_SLOW5:
    s_nop 15
    s_nop 7
    v_max3_f32 v22, v128, v129, v130
    v_max3_f32 v23, v131, v132, v133
    v_max3_f32 v22, v22, v134, v135
    v_max3_f32 v23, v23, v136, v137
    v_max3_f32 v22, v22, v138, v139
    v_max3_f32 v23, v23, v140, v141
    v_max3_f32 v22, v22, v142, v143
    v_max3_f32 v23, v23, v144, v145
    v_max3_f32 v22, v22, v146, v147
    v_max3_f32 v23, v23, v148, v149
    v_max3_f32 v22, v22, v150, v151
    v_max3_f32 v23, v23, v152, v153
    v_max3_f32 v22, v22, v154, v155
    v_max3_f32 v23, v23, v156, v157
    v_max3_f32 v22, v22, v158, v159
    v_max_f32 v22, v22, v23
    v_mov_b32 v23, v22
    s_nop 1
    v_permlane32_swap_b32 v22, v23
    v_max_f32 v22, v22, v23
    v_max_f32 v22, 0, v22
    v_sub_f32 v23, 0, v22
    v_exp_f32 v23, v23
    s_nop 0
    v_mul_f32 v160, v23, v160
    v_mul_f32 v161, v23, v161
    v_mul_f32 v162, v23, v162
    v_mul_f32 v163, v23, v163
    v_mul_f32 v164, v23, v164
    v_mul_f32 v165, v23, v165
    v_mul_f32 v166, v23, v166
    v_mul_f32 v167, v23, v167
    v_mul_f32 v168, v23, v168
    v_mul_f32 v169, v23, v169
    v_mul_f32 v170, v23, v170
    v_mul_f32 v171, v23, v171
    v_mul_f32 v172, v23, v172
    v_mul_f32 v173, v23, v173
    v_mul_f32 v174, v23, v174
    v_mul_f32 v175, v23, v175
    v_mul_f32 v176, v23, v176
    v_mul_f32 v177, v23, v177
    v_mul_f32 v178, v23, v178
    v_mul_f32 v179, v23, v179
    v_mul_f32 v180, v23, v180
    v_mul_f32 v181, v23, v181
    v_mul_f32 v182, v23, v182
    v_mul_f32 v183, v23, v183
    v_mul_f32 v184, v23, v184
    v_mul_f32 v185, v23, v185
    v_mul_f32 v186, v23, v186
    v_mul_f32 v187, v23, v187
    v_mul_f32 v188, v23, v188
    v_mul_f32 v189, v23, v189
    v_mul_f32 v190, v23, v190
    v_mul_f32 v191, v23, v191
    v_mul_f32 v192, v23, v192
    v_mul_f32 v193, v23, v193
    v_mul_f32 v194, v23, v194
    v_mul_f32 v195, v23, v195
    v_mul_f32 v196, v23, v196
    v_mul_f32 v197, v23, v197
    v_mul_f32 v198, v23, v198
    v_mul_f32 v199, v23, v199
    v_mul_f32 v200, v23, v200
    v_mul_f32 v201, v23, v201
    v_mul_f32 v202, v23, v202
    v_mul_f32 v203, v23, v203
    v_mul_f32 v204, v23, v204
    v_mul_f32 v205, v23, v205
    v_mul_f32 v206, v23, v206
    v_mul_f32 v207, v23, v207
    v_mul_f32 v208, v23, v208
    v_mul_f32 v209, v23, v209
    v_mul_f32 v210, v23, v210
    v_mul_f32 v211, v23, v211
    v_mul_f32 v212, v23, v212
    v_mul_f32 v213, v23, v213
    v_mul_f32 v214, v23, v214
    v_mul_f32 v215, v23, v215
    v_mul_f32 v216, v23, v216
    v_mul_f32 v217, v23, v217
    v_mul_f32 v218, v23, v218
    v_mul_f32 v219, v23, v219
    v_mul_f32 v220, v23, v220
    v_mul_f32 v221, v23, v221
    v_mul_f32 v222, v23, v222
    v_mul_f32 v223, v23, v223
    v_mul_f32 v18, v23, v18
    v_sub_f32 v48, v48, v22
    v_sub_f32 v49, v49, v22
    v_sub_f32 v50, v50, v22
    v_sub_f32 v51, v51, v22
    v_sub_f32 v52, v52, v22
    v_sub_f32 v53, v53, v22
    v_sub_f32 v54, v54, v22
    v_sub_f32 v55, v55, v22
    v_sub_f32 v56, v56, v22
    v_sub_f32 v57, v57, v22
    v_sub_f32 v58, v58, v22
    v_sub_f32 v59, v59, v22
    v_sub_f32 v60, v60, v22
    v_sub_f32 v61, v61, v22
    v_sub_f32 v62, v62, v22
    v_sub_f32 v63, v63, v22
    v_sub_f32 v96, v96, v22
    v_sub_f32 v97, v97, v22
    v_sub_f32 v98, v98, v22
    v_sub_f32 v99, v99, v22
    v_sub_f32 v100, v100, v22
    v_sub_f32 v101, v101, v22
    v_sub_f32 v102, v102, v22
    v_sub_f32 v103, v103, v22
    v_sub_f32 v104, v104, v22
    v_sub_f32 v105, v105, v22
    v_sub_f32 v106, v106, v22
    v_sub_f32 v107, v107, v22
    v_sub_f32 v108, v108, v22
    v_sub_f32 v109, v109, v22
    v_sub_f32 v110, v110, v22
    v_sub_f32 v111, v111, v22
    v_sub_f32 v112, v112, v22
    v_sub_f32 v113, v113, v22
    v_sub_f32 v114, v114, v22
    v_sub_f32 v115, v115, v22
    v_sub_f32 v116, v116, v22
    v_sub_f32 v117, v117, v22
    v_sub_f32 v118, v118, v22
    v_sub_f32 v119, v119, v22
    v_sub_f32 v120, v120, v22
    v_sub_f32 v121, v121, v22
    v_sub_f32 v122, v122, v22
    v_sub_f32 v123, v123, v22
    v_sub_f32 v124, v124, v22
    v_sub_f32 v125, v125, v22
    v_sub_f32 v126, v126, v22
    v_sub_f32 v127, v127, v22
    v_sub_f32 v128, v128, v22
    v_sub_f32 v129, v129, v22
    v_exp_f32 v0, v128
    v_sub_f32 v130, v130, v22
    v_exp_f32 v1, v129
    v_mov_b32 v20, v0
    v_sub_f32 v131, v131, v22
    v_exp_f32 v2, v130
    v_mov_b32 v21, v1
    v_cvt_pk_bf16_f32 v240, v0, v1
    v_sub_f32 v132, v132, v22
    v_exp_f32 v3, v131
    v_add_f32 v20, v20, v2
    v_sub_f32 v133, v133, v22
    v_exp_f32 v0, v132
    v_add_f32 v21, v21, v3
    v_cvt_pk_bf16_f32 v241, v2, v3
    v_sub_f32 v134, v134, v22
    v_exp_f32 v1, v133
    v_add_f32 v20, v20, v0
    v_sub_f32 v135, v135, v22
    v_exp_f32 v2, v134
    v_add_f32 v21, v21, v1
    v_cvt_pk_bf16_f32 v242, v0, v1
    v_sub_f32 v136, v136, v22
    v_exp_f32 v3, v135
    v_add_f32 v20, v20, v2
    v_sub_f32 v137, v137, v22
    v_exp_f32 v0, v136
    v_add_f32 v21, v21, v3
    v_cvt_pk_bf16_f32 v243, v2, v3
    v_sub_f32 v138, v138, v22
    v_exp_f32 v1, v137
    v_add_f32 v20, v20, v0
    v_sub_f32 v139, v139, v22
    v_exp_f32 v2, v138
    v_add_f32 v21, v21, v1
    v_cvt_pk_bf16_f32 v244, v0, v1
    v_sub_f32 v140, v140, v22
    v_exp_f32 v3, v139
    v_add_f32 v20, v20, v2
    v_sub_f32 v141, v141, v22
    v_exp_f32 v0, v140
    v_add_f32 v21, v21, v3
    v_cvt_pk_bf16_f32 v245, v2, v3
    v_sub_f32 v142, v142, v22
    v_exp_f32 v1, v141
    v_add_f32 v20, v20, v0
    v_sub_f32 v143, v143, v22
    v_exp_f32 v2, v142
    v_add_f32 v21, v21, v1
    v_cvt_pk_bf16_f32 v246, v0, v1
    v_sub_f32 v144, v144, v22
    v_exp_f32 v3, v143
    v_add_f32 v20, v20, v2
    v_sub_f32 v145, v145, v22
    v_exp_f32 v0, v144
    v_add_f32 v21, v21, v3
    v_cvt_pk_bf16_f32 v247, v2, v3
    v_sub_f32 v146, v146, v22
    v_exp_f32 v1, v145
    v_add_f32 v20, v20, v0
    v_sub_f32 v147, v147, v22
    v_exp_f32 v2, v146
    v_add_f32 v21, v21, v1
    v_cvt_pk_bf16_f32 v248, v0, v1
    v_sub_f32 v148, v148, v22
    v_exp_f32 v3, v147
    v_add_f32 v20, v20, v2
    v_sub_f32 v149, v149, v22
    v_exp_f32 v0, v148
    v_add_f32 v21, v21, v3
    v_cvt_pk_bf16_f32 v249, v2, v3
    v_sub_f32 v150, v150, v22
    v_exp_f32 v1, v149
    v_add_f32 v20, v20, v0
    v_sub_f32 v151, v151, v22
    v_exp_f32 v2, v150
    v_add_f32 v21, v21, v1
    v_cvt_pk_bf16_f32 v250, v0, v1
    v_sub_f32 v152, v152, v22
    v_exp_f32 v3, v151
    v_add_f32 v20, v20, v2
    v_sub_f32 v153, v153, v22
    v_exp_f32 v0, v152
    v_add_f32 v21, v21, v3
    v_cvt_pk_bf16_f32 v251, v2, v3
    v_sub_f32 v154, v154, v22
    v_exp_f32 v1, v153
    v_add_f32 v20, v20, v0
    v_sub_f32 v155, v155, v22
    v_exp_f32 v2, v154
    v_add_f32 v21, v21, v1
    v_cvt_pk_bf16_f32 v252, v0, v1
    v_sub_f32 v156, v156, v22
    v_exp_f32 v3, v155
    v_add_f32 v20, v20, v2
    v_sub_f32 v157, v157, v22
    v_exp_f32 v0, v156
    v_add_f32 v21, v21, v3
    v_cvt_pk_bf16_f32 v253, v2, v3
    v_sub_f32 v158, v158, v22
    v_exp_f32 v1, v157
    v_add_f32 v20, v20, v0
    v_sub_f32 v159, v159, v22
    v_exp_f32 v2, v158
    v_add_f32 v21, v21, v1
    v_cvt_pk_bf16_f32 v254, v0, v1
    v_exp_f32 v3, v159
    v_add_f32 v20, v20, v2
    v_add_f32 v21, v21, v3
    v_cvt_pk_bf16_f32 v255, v2, v3
    v_add_f32 v20, v20, v21
    s_nop 15
    s_nop 7
    s_branch K1_BACK5
K1_SLOW6:
    s_nop 15
    s_nop 7
    v_max3_f32 v22, v96, v97, v98
    v_max3_f32 v23, v99, v100, v101
    v_max3_f32 v22, v22, v102, v103
    v_max3_f32 v23, v23, v104, v105
    v_max3_f32 v22, v22, v106, v107
    v_max3_f32 v23, v23, v108, v109
    v_max3_f32 v22, v22, v110, v111
    v_max3_f32 v23, v23, v112, v113
    v_max3_f32 v22, v22, v114, v115
    v_max3_f32 v23, v23, v116, v117
    v_max3_f32 v22, v22, v118, v119
    v_max3_f32 v23, v23, v120, v121
    v_max3_f32 v22, v22, v122, v123
    v_max3_f32 v23, v23, v124, v125
    v_max3_f32 v22, v22, v126, v127
    v_max_f32 v22, v22, v23
    v_mov_b32 v23, v22
    s_nop 1
    v_permlane32_swap_b32 v22, v23
    v_max_f32 v22, v22, v23
    v_max_f32 v22, 0, v22
    v_sub_f32 v23, 0, v22
    v_exp_f32 v23, v23
    s_nop 0
    v_mul_f32 v160, v23, v160
    v_mul_f32 v161, v23, v161
    v_mul_f32 v162, v23, v162
    v_mul_f32 v163, v23, v163
    v_mul_f32 v164, v23, v164
    v_mul_f32 v165, v23, v165
    v_mul_f32 v166, v23, v166
    v_mul_f32 v167, v23, v167
    v_mul_f32 v168, v23, v168
    v_mul_f32 v169, v23, v169
    v_mul_f32 v170, v23, v170
    v_mul_f32 v171, v23, v171
    v_mul_f32 v172, v23, v172
    v_mul_f32 v173, v23, v173
    v_mul_f32 v174, v23, v174
    v_mul_f32 v175, v23, v175
    v_mul_f32 v176, v23, v176
    v_mul_f32 v177, v23, v177
    v_mul_f32 v178, v23, v178
    v_mul_f32 v179, v23, v179
    v_mul_f32 v180, v23, v180
    v_mul_f32 v181, v23, v181
    v_mul_f32 v182, v23, v182
    v_mul_f32 v183, v23, v183
    v_mul_f32 v184, v23, v184
    v_mul_f32 v185, v23, v185
    v_mul_f32 v186, v23, v186
    v_mul_f32 v187, v23, v187
    v_mul_f32 v188, v23, v188
    v_mul_f32 v189, v23, v189
    v_mul_f32 v190, v23, v190
    v_mul_f32 v191, v23, v191
    v_mul_f32 v192, v23, v192
    v_mul_f32 v193, v23, v193
    v_mul_f32 v194, v23, v194
    v_mul_f32 v195, v23, v195
    v_mul_f32 v196, v23, v196
    v_mul_f32 v197, v23, v197
    v_mul_f32 v198, v23, v198
    v_mul_f32 v199, v23, v199
    v_mul_f32 v200, v23, v200
    v_mul_f32 v201, v23, v201
    v_mul_f32 v202, v23, v202
    v_mul_f32 v203, v23, v203
    v_mul_f32 v204, v23, v204
    v_mul_f32 v205, v23, v205
    v_mul_f32 v206, v23, v206
    v_mul_f32 v207, v23, v207
    v_mul_f32 v208, v23, v208
    v_mul_f32 v209, v23, v209
    v_mul_f32 v210, v23, v210
    v_mul_f32 v211, v23, v211
    v_mul_f32 v212, v23, v212
    v_mul_f32 v213, v23, v213
    v_mul_f32 v214, v23, v214
    v_mul_f32 v215, v23, v215
    v_mul_f32 v216, v23, v216
    v_mul_f32 v217, v23, v217
    v_mul_f32 v218, v23, v218
    v_mul_f32 v219, v23, v219
    v_mul_f32 v220, v23, v220
    v_mul_f32 v221, v23, v221
    v_mul_f32 v222, v23, v222
    v_mul_f32 v223, v23, v223
    v_mul_f32 v18, v23, v18
    v_sub_f32 v48, v48, v22
    v_sub_f32 v49, v49, v22
    v_sub_f32 v50, v50, v22
    v_sub_f32 v51, v51, v22
    v_sub_f32 v52, v52, v22
    v_sub_f32 v53, v53, v22
    v_sub_f32 v54, v54, v22
    v_sub_f32 v55, v55, v22
    v_sub_f32 v56, v56, v22
    v_sub_f32 v57, v57, v22
    v_sub_f32 v58, v58, v22
    v_sub_f32 v59, v59, v22
    v_sub_f32 v60, v60, v22
    v_sub_f32 v61, v61, v22
    v_sub_f32 v62, v62, v22
    v_sub_f32 v63, v63, v22
    v_sub_f32 v128, v128, v22
    v_sub_f32 v129, v129, v22
    v_sub_f32 v130, v130, v22
    v_sub_f32 v131, v131, v22
    v_sub_f32 v132, v132, v22
    v_sub_f32 v133, v133, v22
    v_sub_f32 v134, v134, v22
    v_sub_f32 v135, v135, v22
    v_sub_f32 v136, v136, v22
    v_sub_f32 v137, v137, v22
    v_sub_f32 v138, v138, v22
    v_sub_f32 v139, v139, v22
    v_sub_f32 v140, v140, v22
    v_sub_f32 v141, v141, v22
    v_sub_f32 v142, v142, v22
    v_sub_f32 v143, v143, v22
    v_sub_f32 v144, v144, v22
    v_sub_f32 v145, v145, v22
    v_sub_f32 v146, v146, v22
    v_sub_f32 v147, v147, v22
    v_sub_f32 v148, v148, v22
    v_sub_f32 v149, v149, v22
    v_sub_f32 v150, v150, v22
    v_sub_f32 v151, v151, v22
    v_sub_f32 v152, v152, v22
    v_sub_f32 v153, v153, v22
    v_sub_f32 v154, v154, v22
    v_sub_f32 v155, v155, v22
    v_sub_f32 v156, v156, v22
    v_sub_f32 v157, v157, v22
    v_sub_f32 v158, v158, v22
    v_sub_f32 v159, v159, v22
    v_sub_f32 v96, v96, v22
    v_sub_f32 v97, v97, v22
    v_exp_f32 v0, v96
    v_sub_f32 v98, v98, v22
    v_exp_f32 v1, v97
    v_mov_b32 v20, v0
    v_sub_f32 v99, v99, v22
    v_exp_f32 v2, v98
    v_mov_b32 v21, v1
    v_cvt_pk_bf16_f32 v224, v0, v1
    v_sub_f32 v100, v100, v22
    v_exp_f32 v3, v99
    v_add_f32 v20, v20, v2
    v_sub_f32 v101, v101, v22
    v_exp_f32 v0, v100
    v_add_f32 v21, v21, v3
    v_cvt_pk_bf16_f32 v225, v2, v3
    v_sub_f32 v102, v102, v22
    v_exp_f32 v1, v101
    v_add_f32 v20, v20, v0
    v_sub_f32 v103, v103, v22
    v_exp_f32 v2, v102
    v_add_f32 v21, v21, v1
    v_cvt_pk_bf16_f32 v226, v0, v1
    v_sub_f32 v104, v104, v22
    v_exp_f32 v3, v103
    v_add_f32 v20, v20, v2
    v_sub_f32 v105, v105, v22
    v_exp_f32 v0, v104
    v_add_f32 v21, v21, v3
    v_cvt_pk_bf16_f32 v227, v2, v3
    v_sub_f32 v106, v106, v22
    v_exp_f32 v1, v105
    v_add_f32 v20, v20, v0
    v_sub_f32 v107, v107, v22
    v_exp_f32 v2, v106
    v_add_f32 v21, v21, v1
    v_cvt_pk_bf16_f32 v228, v0, v1
    v_sub_f32 v108, v108, v22
    v_exp_f32 v3, v107
    v_add_f32 v20, v20, v2
    v_sub_f32 v109, v109, v22
    v_exp_f32 v0, v108
    v_add_f32 v21, v21, v3
    v_cvt_pk_bf16_f32 v229, v2, v3
    v_sub_f32 v110, v110, v22
    v_exp_f32 v1, v109
    v_add_f32 v20, v20, v0
    v_sub_f32 v111, v111, v22
    v_exp_f32 v2, v110
    v_add_f32 v21, v21, v1
    v_cvt_pk_bf16_f32 v230, v0, v1
    v_sub_f32 v112, v112, v22
    v_exp_f32 v3, v111
    v_add_f32 v20, v20, v2
    v_sub_f32 v113, v113, v22
    v_exp_f32 v0, v112
    v_add_f32 v21, v21, v3
    v_cvt_pk_bf16_f32 v231, v2, v3
    v_sub_f32 v114, v114, v22
    v_exp_f32 v1, v113
    v_add_f32 v20, v20, v0
    v_sub_f32 v115, v115, v22
    v_exp_f32 v2, v114
    v_add_f32 v21, v21, v1
    v_cvt_pk_bf16_f32 v232, v0, v1
    v_sub_f32 v116, v116, v22
    v_exp_f32 v3, v115
    v_add_f32 v20, v20, v2
    v_sub_f32 v117, v117, v22
    v_exp_f32 v0, v116
    v_add_f32 v21, v21, v3
    v_cvt_pk_bf16_f32 v233, v2, v3
    v_sub_f32 v118, v118, v22
    v_exp_f32 v1, v117
    v_add_f32 v20, v20, v0
    v_sub_f32 v119, v119, v22
    v_exp_f32 v2, v118
    v_add_f32 v21, v21, v1
    v_cvt_pk_bf16_f32 v234, v0, v1
    v_sub_f32 v120, v120, v22
    v_exp_f32 v3, v119
    v_add_f32 v20, v20, v2
    v_sub_f32 v121, v121, v22
    v_exp_f32 v0, v120
    v_add_f32 v21, v21, v3
    v_cvt_pk_bf16_f32 v235, v2, v3
    v_sub_f32 v122, v122, v22
    v_exp_f32 v1, v121
    v_add_f32 v20, v20, v0
    v_sub_f32 v123, v123, v22
    v_exp_f32 v2, v122
    v_add_f32 v21, v21, v1
    v_cvt_pk_bf16_f32 v236, v0, v1
    v_sub_f32 v124, v124, v22
    v_exp_f32 v3, v123
    v_add_f32 v20, v20, v2
    v_sub_f32 v125, v125, v22
    v_exp_f32 v0, v124
    v_add_f32 v21, v21, v3
    v_cvt_pk_bf16_f32 v237, v2, v3
    v_sub_f32 v126, v126, v22
    v_exp_f32 v1, v125
    v_add_f32 v20, v20, v0
    v_sub_f32 v127, v127, v22
    v_exp_f32 v2, v126
    v_add_f32 v21, v21, v1
    v_cvt_pk_bf16_f32 v238, v0, v1
    v_exp_f32 v3, v127
    v_add_f32 v20, v20, v2
    v_add_f32 v21, v21, v3
    v_cvt_pk_bf16_f32 v239, v2, v3
    v_add_f32 v20, v20, v21
    s_nop 15
    s_nop 7
    s_branch K1_BACK6
K1_SLOW7:
    s_nop 15
    s_nop 7
    v_max3_f32 v22, v128, v129, v130
    v_max3_f32 v23, v131, v132, v133
    v_max3_f32 v22, v22, v134, v135
    v_max3_f32 v23, v23, v136, v137
    v_max3_f32 v22, v22, v138, v139
    v_max3_f32 v23, v23, v140, v141
    v_max3_f32 v22, v22, v142, v143
    v_max3_f32 v23, v23, v144, v145
    v_max3_f32 v22, v22, v146, v147
    v_max3_f32 v23, v23, v148, v149
    v_max3_f32 v22, v22, v150, v151
    v_max3_f32 v23, v23, v152, v153
    v_max3_f32 v22, v22, v154, v155
    v_max3_f32 v23, v23, v156, v157
    v_max3_f32 v22, v22, v158, v159
    v_max_f32 v22, v22, v23
    v_mov_b32 v23, v22
    s_nop 1
    v_permlane32_swap_b32 v22, v23
    v_max_f32 v22, v22, v23
    v_max_f32 v22, 0, v22
    v_sub_f32 v23, 0, v22
    v_exp_f32 v23, v23
    s_nop 0
    v_mul_f32 v160, v23, v160
    v_mul_f32 v161, v23, v161
    v_mul_f32 v162, v23, v162
    v_mul_f32 v163, v23, v163
    v_mul_f32 v164, v23, v164
    v_mul_f32 v165, v23, v165
    v_mul_f32 v166, v23, v166
    v_mul_f32 v167, v23, v167
    v_mul_f32 v168, v23, v168
    v_mul_f32 v169, v23, v169
    v_mul_f32 v170, v23, v170
    v_mul_f32 v171, v23, v171
    v_mul_f32 v172, v23, v172
    v_mul_f32 v173, v23, v173
    v_mul_f32 v174, v23, v174
    v_mul_f32 v175, v23, v175
    v_mul_f32 v176, v23, v176
    v_mul_f32 v177, v23, v177
    v_mul_f32 v178, v23, v178
    v_mul_f32 v179, v23, v179
    v_mul_f32 v180, v23, v180
    v_mul_f32 v181, v23, v181
    v_mul_f32 v182, v23, v182
    v_mul_f32 v183, v23, v183
    v_mul_f32 v184, v23, v184
    v_mul_f32 v185, v23, v185
    v_mul_f32 v186, v23, v186
    v_mul_f32 v187, v23, v187
    v_mul_f32 v188, v23, v188
    v_mul_f32 v189, v23, v189
    v_mul_f32 v190, v23, v190
    v_mul_f32 v191, v23, v191
    v_mul_f32 v192, v23, v192
    v_mul_f32 v193, v23, v193
    v_mul_f32 v194, v23, v194
    v_mul_f32 v195, v23, v195
    v_mul_f32 v196, v23, v196
    v_mul_f32 v197, v23, v197
    v_mul_f32 v198, v23, v198
    v_mul_f32 v199, v23, v199
    v_mul_f32 v200, v23, v200
    v_mul_f32 v201, v23, v201
    v_mul_f32 v202, v23, v202
    v_mul_f32 v203, v23, v203
    v_mul_f32 v204, v23, v204
    v_mul_f32 v205, v23, v205
    v_mul_f32 v206, v23, v206
    v_mul_f32 v207, v23, v207
    v_mul_f32 v208, v23, v208
    v_mul_f32 v209, v23, v209
    v_mul_f32 v210, v23, v210
    v_mul_f32 v211, v23, v211
    v_mul_f32 v212, v23, v212
    v_mul_f32 v213, v23, v213
    v_mul_f32 v214, v23, v214
    v_mul_f32 v215, v23, v215
    v_mul_f32 v216, v23, v216
    v_mul_f32 v217, v23, v217
    v_mul_f32 v218, v23, v218
    v_mul_f32 v219, v23, v219
    v_mul_f32 v220, v23, v220
    v_mul_f32 v221, v23, v221
    v_mul_f32 v222, v23, v222
    v_mul_f32 v223, v23, v223
    v_mul_f32 v18, v23, v18
    v_sub_f32 v48, v48, v22
    v_sub_f32 v49, v49, v22
    v_sub_f32 v50, v50, v22
    v_sub_f32 v51, v51, v22
    v_sub_f32 v52, v52, v22
    v_sub_f32 v53, v53, v22
    v_sub_f32 v54, v54, v22
    v_sub_f32 v55, v55, v22
    v_sub_f32 v56, v56, v22
    v_sub_f32 v57, v57, v22
    v_sub_f32 v58, v58, v22
    v_sub_f32 v59, v59, v22
    v_sub_f32 v60, v60, v22
    v_sub_f32 v61, v61, v22
    v_sub_f32 v62, v62, v22
    v_sub_f32 v63, v63, v22
    v_sub_f32 v128, v128, v22
    v_sub_f32 v129, v129, v22
    v_exp_f32 v0, v128
    v_sub_f32 v130, v130, v22
    v_exp_f32 v1, v129
    v_mov_b32 v20, v0
    v_sub_f32 v131, v131, v22
    v_exp_f32 v2, v130
    v_mov_b32 v21, v1
    v_cvt_pk_bf16_f32 v240, v0, v1
    v_sub_f32 v132, v132, v22
    v_exp_f32 v3, v131
    v_add_f32 v20, v20, v2
    v_sub_f32 v133, v133, v22
    v_exp_f32 v0, v132
    v_add_f32 v21, v21, v3
    v_cvt_pk_bf16_f32 v241, v2, v3
    v_sub_f32 v134, v134, v22
    v_exp_f32 v1, v133
    v_add_f32 v20, v20, v0
    v_sub_f32 v135, v135, v22
    v_exp_f32 v2, v134
    v_add_f32 v21, v21, v1
    v_cvt_pk_bf16_f32 v242, v0, v1
    v_sub_f32 v136, v136, v22
    v_exp_f32 v3, v135
    v_add_f32 v20, v20, v2
    v_sub_f32 v137, v137, v22
    v_exp_f32 v0, v136
    v_add_f32 v21, v21, v3
    v_cvt_pk_bf16_f32 v243, v2, v3
    v_sub_f32 v138, v138, v22
    v_exp_f32 v1, v137
    v_add_f32 v20, v20, v0
    v_sub_f32 v139, v139, v22
    v_exp_f32 v2, v138
    v_add_f32 v21, v21, v1
    v_cvt_pk_bf16_f32 v244, v0, v1
    v_sub_f32 v140, v140, v22
    v_exp_f32 v3, v139
    v_add_f32 v20, v20, v2
    v_sub_f32 v141, v141, v22
    v_exp_f32 v0, v140
    v_add_f32 v21, v21, v3
    v_cvt_pk_bf16_f32 v245, v2, v3
    v_sub_f32 v142, v142, v22
    v_exp_f32 v1, v141
    v_add_f32 v20, v20, v0
    v_sub_f32 v143, v143, v22
    v_exp_f32 v2, v142
    v_add_f32 v21, v21, v1
    v_cvt_pk_bf16_f32 v246, v0, v1
    v_sub_f32 v144, v144, v22
    v_exp_f32 v3, v143
    v_add_f32 v20, v20, v2
    v_sub_f32 v145, v145, v22
    v_exp_f32 v0, v144
    v_add_f32 v21, v21, v3
    v_cvt_pk_bf16_f32 v247, v2, v3
    v_sub_f32 v146, v146, v22
    v_exp_f32 v1, v145
    v_add_f32 v20, v20, v0
    v_sub_f32 v147, v147, v22
    v_exp_f32 v2, v146
    v_add_f32 v21, v21, v1
    v_cvt_pk_bf16_f32 v248, v0, v1
    v_sub_f32 v148, v148, v22
    v_exp_f32 v3, v147
    v_add_f32 v20, v20, v2
    v_sub_f32 v149, v149, v22
    v_exp_f32 v0, v148
    v_add_f32 v21, v21, v3
    v_cvt_pk_bf16_f32 v249, v2, v3
    v_sub_f32 v150, v150, v22
    v_exp_f32 v1, v149
    v_add_f32 v20, v20, v0
    v_sub_f32 v151, v151, v22
    v_exp_f32 v2, v150
    v_add_f32 v21, v21, v1
    v_cvt_pk_bf16_f32 v250, v0, v1
    v_sub_f32 v152, v152, v22
    v_exp_f32 v3, v151
    v_add_f32 v20, v20, v2
    v_sub_f32 v153, v153, v22
    v_exp_f32 v0, v152
    v_add_f32 v21, v21, v3
    v_cvt_pk_bf16_f32 v251, v2, v3
    v_sub_f32 v154, v154, v22
    v_exp_f32 v1, v153
    v_add_f32 v20, v20, v0
    v_sub_f32 v155, v155, v22
    v_exp_f32 v2, v154
    v_add_f32 v21, v21, v1
    v_cvt_pk_bf16_f32 v252, v0, v1
    v_sub_f32 v156, v156, v22
    v_exp_f32 v3, v155
    v_add_f32 v20, v20, v2
    v_sub_f32 v157, v157, v22
    v_exp_f32 v0, v156
    v_add_f32 v21, v21, v3
    v_cvt_pk_bf16_f32 v253, v2, v3
    v_sub_f32 v158, v158, v22
    v_exp_f32 v1, v157
    v_add_f32 v20, v20, v0
    v_sub_f32 v159, v159, v22
    v_exp_f32 v2, v158
    v_add_f32 v21, v21, v1
    v_cvt_pk_bf16_f32 v254, v0, v1
    v_exp_f32 v3, v159
    v_add_f32 v20, v20, v2
    v_add_f32 v21, v21, v3
    v_cvt_pk_bf16_f32 v255, v2, v3
    v_add_f32 v20, v20, v21
    s_nop 15
    s_nop 7
    s_branch K1_BACK7

.section .rodata,"a"
.p2align 6
.amdhsa_kernel k1_kernel
  .amdhsa_next_free_vgpr 256
  .amdhsa_next_free_sgpr 64
  .amdhsa_accum_offset 256
  .amdhsa_group_segment_fixed_size 0
  .amdhsa_kernarg_size 104
  .amdhsa_user_sgpr_count 2
  .amdhsa_user_sgpr_kernarg_segment_ptr 1
  .amdhsa_system_sgpr_workgroup_id_x 1
.end_amdhsa_kernel
```
